```python
import torch

def _softmax(x, axis=-1):
    return torch.softmax(x, dim=axis)
def _gelu(x):
    return torch.nn.functional.gelu(x, approximate="tanh")
def _silu(x):
    return torch.nn.functional.silu(x)
def _sigmoid(x):
    return torch.sigmoid(x)
def _layernorm(x, axis=-1, eps=1e-5):
    m = x.mean(dim=axis, keepdim=True)
    v = x.var(dim=axis, keepdim=True, unbiased=False)
    return (x - m) / torch.sqrt(v + eps)
def _scatter_add(tgt, idx, src, axis=0):
    return tgt.clone().index_add_(axis, idx, src)
def _segment_sum(src, seg, n):
    out = torch.zeros((n,) + src.shape[1:], dtype=src.dtype)
    return out.index_add_(0, seg, src)
def _pad(x, pw):
    flat = tuple(v for pair in reversed(pw) for v in pair)
    return torch.nn.functional.pad(x, flat)

kernel_name = 'standalone__w4a16_gemm_dequant__prompt'

def setup_inputs():

    _w = (lambda a: (lambda t: t.to(torch.bfloat16) if t.is_floating_point() else t)(torch.as_tensor(a)))
    B, S, D, F = 1, 2048, 1024, 3584
    G = -1 if -1 > 0 else D
    D = (D // G) * G
    ng = D // G
    qw = torch.randint(0, 16, (D, F)).to(torch.int32)
    return {
        "x": _w((lambda *s: torch.randn(*s, dtype=torch.bfloat16) * 0.05)(B, S, D)),
        "qw": _w(qw),
        "scales": _w(torch.abs((lambda *s: torch.randn(*s, dtype=torch.bfloat16) * 0.05)(ng, F)) + 0.01),
        "zeros": _w(torch.full((ng, F), 8.0, dtype=float)),
    }

def reference(x, qw, scales, zeros):
    B, S, D = x.shape
    ng, F = scales.shape
    G = D // ng
    s = (lambda x, n, axis: torch.repeat_interleave(x, n, dim=axis))(scales, G, axis=0)
    z = (lambda x, n, axis: torch.repeat_interleave(x, n, dim=axis))(zeros, G, axis=0)
    w = ((lambda x, dt: x.to(dt))(qw, x.dtype) - z) * s
    return x @ w
```

```asm
; @launch grid=(256,1,1) block=(512,1,1) lds=158976
.amdgcn_target "amdgcn-amd-amdhsa--gfx950"
.text
.globl standalone__w4a16_gemm_dequant__prompt_kernel
.p2align 8
.type standalone__w4a16_gemm_dequant__prompt_kernel,@function
standalone__w4a16_gemm_dequant__prompt_kernel:
    s_cmp_ge_u32 s2, 256
    s_cbranch_scc1 L_end
    s_load_dwordx2 s[22:23], s[0:1], 48
    s_load_dwordx4 s[4:7], s[0:1], 0
    s_load_dwordx4 s[16:19], s[0:1], 16
    s_load_dwordx2 s[20:21], s[0:1], 32
    s_getpc_b64 s[88:89]
L_pc:
    v_cmp_gt_u32 vcc, 4, v0
    s_lshr_b32 s34, s2, 3
    s_lshl_b32 s34, s34, 2
    s_and_saveexec_b64 s[36:37], vcc
    s_cbranch_execz L_nocpf
    v_add_u32 v4, s34, v0
    v_lshlrev_b32 v4, 7, v4
    v_min_u32 v4, L_end-L_pc, v4
    v_mov_b32 v5, s89
    v_add_co_u32 v4, vcc, s88, v4
    s_nop 1
    v_addc_co_u32 v5, vcc, 0, v5, vcc
    global_load_dword v255, v[4:5], off
L_nocpf:
    s_mov_b64 exec, s[36:37]
    v_lshrrev_b32 v1, 6, v0
    v_and_b32 v2, 63, v0
    s_and_b32 s28, s2, 7
    v_readfirstlane_b32 s3, v1
    s_lshl_b32 s31, s28, 1
    s_bfe_u32 s30, s2, 0x10003
    s_add_u32 s31, s31, s30
    s_lshr_b32 s30, s2, 4
    s_mul_i32 s33, s28, 2
    s_and_b32 s33, s33, 15
    s_mov_b32 s90, 200000
    s_cmp_lt_u32 s3, 4
    s_cbranch_scc1 L_cons
    s_cmp_lt_u32 s3, 6
    s_cbranch_scc1 L_load
L_prod:
    s_sub_u32 s40, s3, 6
    s_mov_b32 s39, s40
    v_lshlrev_b32 v12, 4, v2
    v_cmp_gt_u32 vcc, 56, v2
    v_mov_b32 v15, 0x40000000
    s_lshr_b32 s37, s30, 3
    v_cndmask_b32 v12, v15, v12, vcc
    s_add_u32 s37, s37, s33
    s_and_b32 s34, s30, 7
    s_mul_i32 s42, s34, 114688
    s_mul_i32 s35, s31, 896
    s_add_u32 s42, s42, s35
    s_mul_i32 s29, s34, 1792
    s_mul_i32 s35, s31, 229376
    s_add_u32 s29, s29, s35
    s_lshl_b32 s57, s39, 1
    s_add_u32 s57, s57, s37
    s_and_b32 s57, s57, 15
    s_mul_i32 s58, s57, 917504
    s_add_u32 s58, s58, s42
    s_mul_i32 s59, s57, 14336
    s_add_u32 s59, s59, s29
    v_cmp_eq_u32 vcc, 0, v2
    v_mov_b32 v15, 0x40000000
    v_and_b32 v10, 3, v2
    v_cndmask_b32 v13, v15, 0, vcc
    v_lshlrev_b32 v10, 2, v10
    v_add_u32 v10, 156160, v10
    s_lshl_b32 s35, s31, 7
    s_add_u32 s35, s35, 4063232
    s_waitcnt lgkmcnt(0)
    s_load_dword s56, s[22:23], s35
    s_mov_b32 s44, s22
    s_mov_b32 s45, s23
    s_mov_b32 s46, 4214784
    s_mov_b32 s47, 0x00020000
    s_mov_b32 s12, s6
    s_mov_b32 s13, s7
    s_mov_b32 s14, 14680064
    s_mov_b32 s15, 0x00020000
    s_cmp_eq_u32 s40, 0
    s_cbranch_scc1 L_p0
    s_nop 15
    s_nop 15
    s_nop 15
L_p0:
    buffer_load_dwordx4 v[16:19], v12, s[12:15], s58 offen
    s_add_u32 s58, s58, 14336
    buffer_load_dwordx4 v[20:23], v12, s[12:15], s58 offen
    s_add_u32 s58, s58, 14336
    buffer_load_dwordx4 v[24:27], v12, s[12:15], s58 offen
    s_add_u32 s58, s58, 14336
    buffer_load_dwordx4 v[28:31], v12, s[12:15], s58 offen
    s_add_u32 s58, s58, 14336
    buffer_load_dwordx4 v[32:35], v12, s[12:15], s58 offen
    s_add_u32 s58, s58, 14336
    buffer_load_dwordx4 v[36:39], v12, s[12:15], s58 offen
    s_add_u32 s58, s58, 14336
    buffer_load_dwordx4 v[40:43], v12, s[12:15], s58 offen
    s_add_u32 s58, s58, 14336
    buffer_load_dwordx4 v[44:47], v12, s[12:15], s58 offen
    s_lshl_b32 s34, s31, 3
    s_add_u32 s34, s34, s40
    s_mul_i32 s43, s34, 256
    s_add_u32 s43, s43, s30
    s_lshl_b32 s43, s43, 2
    s_add_u32 s43, s43, 3670016
    s_lshl_b32 s41, s34, 4
    s_add_u32 s41, s41, s30
    s_lshl_b32 s41, s41, 7
    s_add_u32 s41, s41, 3801088
    v_cmp_gt_u32 vcc, 16, v2
    v_lshlrev_b32 v56, 6, v2
    v_mov_b32 v57, 0x80808080
    v_cndmask_b32 v56, v15, v56, vcc
    s_add_u32 s39, s39, 2
    s_waitcnt lgkmcnt(0)
    s_mul_i32 s56, s56, 0x9e3779b1
    s_add_u32 s56, s56, 0x7f4a7c15
    v_mov_b32 v14, s56
    s_waitcnt vmcnt(0)
    v_lshl_or_b32 v48, v20, 8, v16
    v_lshl_or_b32 v49, v36, 8, v32
    v_lshl_or_b32 v50, v21, 8, v17
    v_lshl_or_b32 v51, v37, 8, v33
    v_lshl_or_b32 v24, v28, 8, v24
    v_lshl_or_b32 v40, v44, 8, v40
    v_lshl_or_b32 v25, v29, 8, v25
    v_lshl_or_b32 v41, v45, 8, v41
    v_lshl_or_b32 v48, v24, 16, v48
    v_lshl_or_b32 v49, v40, 16, v49
    v_lshl_or_b32 v50, v25, 16, v50
    v_lshl_or_b32 v51, v41, 16, v51
    buffer_store_dwordx4 v[48:51], v12, s[44:47], s59 offen offset:0 sc1
    v_lshl_or_b32 v52, v22, 8, v18
    v_lshl_or_b32 v53, v38, 8, v34
    v_lshl_or_b32 v54, v23, 8, v19
    v_lshl_or_b32 v55, v39, 8, v35
    v_lshl_or_b32 v26, v30, 8, v26
    v_lshl_or_b32 v42, v46, 8, v42
    v_lshl_or_b32 v27, v31, 8, v27
    v_lshl_or_b32 v43, v47, 8, v43
    v_lshl_or_b32 v52, v26, 16, v52
    v_lshl_or_b32 v53, v42, 16, v53
    v_lshl_or_b32 v54, v27, 16, v54
    v_lshl_or_b32 v55, v43, 16, v55
    buffer_store_dwordx4 v[52:55], v12, s[44:47], s59 offen offset:896 sc1
    s_lshl_b32 s57, s39, 1
    s_add_u32 s57, s57, s37
    s_and_b32 s57, s57, 15
    s_mul_i32 s58, s57, 917504
    s_add_u32 s58, s58, s42
    s_mul_i32 s59, s57, 14336
    s_add_u32 s59, s59, s29
    s_waitcnt vmcnt(0)
    buffer_store_dword v14, v56, s[44:47], s43 offen
    s_add_u32 s43, s43, 2048
    s_barrier
    s_cmp_lt_u32 s39, 3
    s_cbranch_scc1 L_p1
    s_barrier
L_p1:
    buffer_load_dwordx4 v[16:19], v12, s[12:15], s58 offen
    s_add_u32 s58, s58, 14336
    buffer_load_dwordx4 v[20:23], v12, s[12:15], s58 offen
    s_add_u32 s58, s58, 14336
    buffer_load_dwordx4 v[24:27], v12, s[12:15], s58 offen
    s_add_u32 s58, s58, 14336
    buffer_load_dwordx4 v[28:31], v12, s[12:15], s58 offen
    s_add_u32 s58, s58, 14336
    buffer_load_dwordx4 v[32:35], v12, s[12:15], s58 offen
    s_add_u32 s58, s58, 14336
    buffer_load_dwordx4 v[36:39], v12, s[12:15], s58 offen
    s_add_u32 s58, s58, 14336
    buffer_load_dwordx4 v[40:43], v12, s[12:15], s58 offen
    s_add_u32 s58, s58, 14336
    buffer_load_dwordx4 v[44:47], v12, s[12:15], s58 offen
    s_cmp_ge_u32 s39, 3
    s_cbranch_scc1 L_p2
    s_barrier
L_p2:
    s_waitcnt vmcnt(0)
    v_lshl_or_b32 v48, v20, 8, v16
    v_lshl_or_b32 v49, v36, 8, v32
    v_lshl_or_b32 v50, v21, 8, v17
    v_lshl_or_b32 v51, v37, 8, v33
    v_lshl_or_b32 v24, v28, 8, v24
    v_lshl_or_b32 v40, v44, 8, v40
    v_lshl_or_b32 v25, v29, 8, v25
    v_lshl_or_b32 v41, v45, 8, v41
    v_lshl_or_b32 v48, v24, 16, v48
    v_lshl_or_b32 v49, v40, 16, v49
    v_lshl_or_b32 v50, v25, 16, v50
    v_lshl_or_b32 v51, v41, 16, v51
    v_lshl_or_b32 v52, v22, 8, v18
    v_lshl_or_b32 v53, v38, 8, v34
    v_lshl_or_b32 v54, v23, 8, v19
    v_lshl_or_b32 v55, v39, 8, v35
    v_lshl_or_b32 v26, v30, 8, v26
    v_lshl_or_b32 v42, v46, 8, v42
    v_lshl_or_b32 v27, v31, 8, v27
    v_lshl_or_b32 v43, v47, 8, v43
    v_lshl_or_b32 v52, v26, 16, v52
    v_lshl_or_b32 v53, v42, 16, v53
    v_lshl_or_b32 v54, v27, 16, v54
    v_lshl_or_b32 v55, v43, 16, v55
    buffer_store_dwordx4 v[48:51], v12, s[44:47], s59 offen offset:0 sc1
    buffer_store_dwordx4 v[52:55], v12, s[44:47], s59 offen offset:896 sc1
    buffer_store_dword v14, v13, s[44:47], s41 offen sc1
    s_add_u32 s41, s41, 4096
    s_waitcnt vmcnt(1)
L_b2:
    buffer_store_dword v14, v56, s[44:47], s43 offen
    s_add_u32 s43, s43, 2048
    buffer_store_dword v14, v13, s[44:47], s41 offen sc1
    s_add_u32 s41, s41, 4096
    s_add_u32 s39, s39, 2
    s_cmp_ge_u32 s39, 8
    s_cbranch_scc1 L_b2e
    s_lshl_b32 s57, s39, 1
    s_add_u32 s57, s57, s37
    s_and_b32 s57, s57, 15
    s_mul_i32 s58, s57, 917504
    s_add_u32 s58, s58, s42
    s_mul_i32 s59, s57, 14336
    s_add_u32 s59, s59, s29
    s_lshl_b32 s38, s39, 1
    s_sub_u32 s38, s38, 8
L_w_1:
    ds_read_b32 v11, v10
    s_waitcnt lgkmcnt(0)
    v_cmp_gt_i32 vcc, s38, v11
    s_cbranch_vccz L_wo_2
    s_sub_u32 s90, s90, 1
    s_cmp_lt_i32 s90, 0
    s_cbranch_scc1 L_wo_2
    s_sleep 2
    s_branch L_w_1
L_wo_2:
    buffer_load_dwordx4 v[16:19], v12, s[12:15], s58 offen
    s_add_u32 s58, s58, 14336
    buffer_load_dwordx4 v[20:23], v12, s[12:15], s58 offen
    s_add_u32 s58, s58, 14336
    buffer_load_dwordx4 v[24:27], v12, s[12:15], s58 offen
    s_add_u32 s58, s58, 14336
    buffer_load_dwordx4 v[28:31], v12, s[12:15], s58 offen
    s_add_u32 s58, s58, 14336
    buffer_load_dwordx4 v[32:35], v12, s[12:15], s58 offen
    s_add_u32 s58, s58, 14336
    buffer_load_dwordx4 v[36:39], v12, s[12:15], s58 offen
    s_add_u32 s58, s58, 14336
    buffer_load_dwordx4 v[40:43], v12, s[12:15], s58 offen
    s_add_u32 s58, s58, 14336
    buffer_load_dwordx4 v[44:47], v12, s[12:15], s58 offen
    s_waitcnt vmcnt(0)
    v_lshl_or_b32 v48, v20, 8, v16
    v_lshl_or_b32 v49, v36, 8, v32
    v_lshl_or_b32 v50, v21, 8, v17
    v_lshl_or_b32 v51, v37, 8, v33
    v_lshl_or_b32 v24, v28, 8, v24
    v_lshl_or_b32 v40, v44, 8, v40
    v_lshl_or_b32 v25, v29, 8, v25
    v_lshl_or_b32 v41, v45, 8, v41
    v_lshl_or_b32 v48, v24, 16, v48
    v_lshl_or_b32 v49, v40, 16, v49
    v_lshl_or_b32 v50, v25, 16, v50
    v_lshl_or_b32 v51, v41, 16, v51
    buffer_store_dwordx4 v[48:51], v12, s[44:47], s59 offen offset:0 sc1
    v_lshl_or_b32 v52, v22, 8, v18
    v_lshl_or_b32 v53, v38, 8, v34
    v_lshl_or_b32 v54, v23, 8, v19
    v_lshl_or_b32 v55, v39, 8, v35
    v_lshl_or_b32 v26, v30, 8, v26
    v_lshl_or_b32 v42, v46, 8, v42
    v_lshl_or_b32 v27, v31, 8, v27
    v_lshl_or_b32 v43, v47, 8, v43
    v_lshl_or_b32 v52, v26, 16, v52
    v_lshl_or_b32 v53, v42, 16, v53
    v_lshl_or_b32 v54, v27, 16, v54
    v_lshl_or_b32 v55, v43, 16, v55
    buffer_store_dwordx4 v[52:55], v12, s[44:47], s59 offen offset:896 sc1
    s_waitcnt vmcnt(0)
    s_branch L_b2
L_b2e:
    s_lshl_b32 s34, s40, 5
    v_and_b32 v4, 31, v2
    v_add_u32 v4, s34, v4
    v_lshlrev_b32 v4, 7, v4
    v_add_u32 v4, L_tail-L_pc, v4
    v_min_u32 v4, L_end-L_pc, v4
    v_mov_b32 v5, s89
    v_add_co_u32 v4, vcc, s88, v4
    s_nop 1
    v_addc_co_u32 v5, vcc, 0, v5, vcc
    global_load_dword v255, v[4:5], off
    s_branch L_help
L_load:
    s_sub_u32 s40, s3, 4
    v_lshrrev_b32 v3, 3, v2
    v_and_b32 v4, 7, v2
    v_xor_b32 v4, v4, v3
    v_lshlrev_b32 v4, 4, v4
    s_lshl_b32 s34, s30, 7
    s_lshl_b32 s35, s40, 6
    s_add_u32 s34, s34, s35
    v_add_u32 v3, s34, v3
    v_lshlrev_b32 v3, 11, v3
    v_add_u32 v16, v3, v4
    v_add_u32 v17, 15360, v16
    v_add_u32 v18, 30720, v16
    v_add_u32 v19, 46080, v16
    s_lshl_b32 s41, s40, 13
    s_mov_b32 s32, s33
    s_mov_b32 s37, s33
    v_lshlrev_b32 v5, 4, v2
    s_mul_i32 s35, s40, 7168
    s_mul_i32 s34, s31, 229376
    s_add_u32 s34, s34, s35
    v_add_u32 v20, s34, v5
    s_add_u32 s42, s35, 16384
    v_and_b32 v22, 15, v2
    v_lshlrev_b32 v21, 2, v22
    v_lshlrev_b32 v22, 7, v22
    s_mul_i32 s43, s31, 8192
    s_add_u32 s43, s43, 3670016
    s_lshl_b32 s57, s40, 8
    s_add_u32 s57, s57, 155648
    v_lshlrev_b32 v6, 2, v2
    v_add_u32 v7, s57, v6
    v_mov_b32 v8, 0
    ds_write_b32 v7, v8
    s_lshl_b32 s58, s2, 1
    s_add_u32 s58, s58, s40
    s_lshl_b32 s58, s58, 8
    s_add_u32 s58, s58, 4083712
    v_add_u32 v9, 1, v2
    v_cmp_eq_u32 vcc, 0, v2
    v_mov_b32 v15, 0x40000000
    v_and_b32 v10, 3, v2
    v_cndmask_b32 v13, v15, 0, vcc
    v_lshlrev_b32 v10, 2, v10
    v_add_u32 v10, 156160, v10
    s_lshl_b32 s35, s31, 7
    s_add_u32 s35, s35, 4063232
    s_waitcnt lgkmcnt(0)
    s_load_dword s56, s[22:23], s35
    s_mov_b32 s44, s22
    s_mov_b32 s45, s23
    s_mov_b32 s46, 4214784
    s_mov_b32 s47, 0x00020000
    s_mov_b32 s8, s4
    s_mov_b32 s9, s5
    s_mov_b32 s10, 4194304
    s_mov_b32 s11, 0x00020000
    buffer_store_dword v9, v6, s[44:47], s58 offen sc1
    s_lshl_b32 s34, s30, 7
    v_add_u32 v23, s34, v13
    s_lshl_b32 s34, s30, 1
    s_add_u32 s34, s34, s40
    s_mul_i32 s34, s34, 256
    s_add_u32 s34, s34, s43
    v_and_b32 v8, 1, v2
    v_lshlrev_b32 v8, 7, v8
    buffer_load_dword v24, v8, s[44:47], s34 offen sc1
    s_lshl_b32 s35, s30, 7
    s_add_u32 s35, s35, 4065280
    s_load_dword s39, s[22:23], s35
    v_mov_b32 v28, 0x3f803f80
    v_mov_b32 v29, 0x3f803f80
    v_mov_b32 v30, 0x3f803f80
    v_mov_b32 v31, 0x3f803f80
    s_nop 15
    s_nop 15
    s_nop 15
    s_nop 15
    s_lshl_b32 s34, s32, 7
    s_add_u32 m0, s41, 0
    s_add_u32 s32, s32, 1
    s_and_b32 s32, s32, 15
    buffer_load_dwordx4 v16, s[8:11], s34 offen offset:0 lds
    buffer_load_dwordx4 v17, s[8:11], s34 offen offset:1024 lds
    buffer_load_dwordx4 v18, s[8:11], s34 offen offset:2048 lds
    buffer_load_dwordx4 v19, s[8:11], s34 offen offset:3072 lds
    s_add_u32 m0, m0, 4096
    s_add_u32 s34, s34, 65536
    buffer_load_dwordx4 v16, s[8:11], s34 offen offset:0 lds
    buffer_load_dwordx4 v17, s[8:11], s34 offen offset:1024 lds
    buffer_load_dwordx4 v18, s[8:11], s34 offen offset:2048 lds
    buffer_load_dwordx4 v19, s[8:11], s34 offen offset:3072 lds
    s_waitcnt lgkmcnt(0)
    s_mul_i32 s56, s56, 0x9e3779b1
    s_add_u32 s56, s56, 0x7f4a7c15
    s_mul_i32 s39, s39, 0x9e3779b1
    s_add_u32 s39, s39, 0x7f4a7c15
    v_mov_b32 v14, s56
    s_mov_b32 s59, 0
    s_mov_b32 s92, s56
    s_mov_b32 s93, s56
    s_waitcnt vmcnt(9)
    s_barrier
    s_lshl_b32 s34, s32, 7
    s_add_u32 m0, s41, 30720
    s_add_u32 s32, s32, 1
    s_and_b32 s32, s32, 15
    buffer_load_dwordx4 v16, s[8:11], s34 offen offset:0 lds
    buffer_load_dwordx4 v17, s[8:11], s34 offen offset:1024 lds
    buffer_load_dwordx4 v18, s[8:11], s34 offen offset:2048 lds
    buffer_load_dwordx4 v19, s[8:11], s34 offen offset:3072 lds
    s_add_u32 m0, m0, 4096
    s_add_u32 s34, s34, 65536
    buffer_load_dwordx4 v16, s[8:11], s34 offen offset:0 lds
    buffer_load_dwordx4 v17, s[8:11], s34 offen offset:1024 lds
    buffer_load_dwordx4 v18, s[8:11], s34 offen offset:2048 lds
    buffer_load_dwordx4 v19, s[8:11], s34 offen offset:3072 lds
    s_mov_b32 s91, 0
    s_mov_b32 s94, s43
L_p_3:
    s_load_dwordx8 s[12:19], s[22:23], s94
    s_load_dwordx8 s[48:55], s[22:23], s94 offset:32
    s_add_u32 s94, s94, 64
    s_add_u32 s91, s91, 1
    s_waitcnt lgkmcnt(0)
    s_xor_b64 s[12:13], s[12:13], s[92:93]
    s_xor_b64 s[14:15], s[14:15], s[92:93]
    s_xor_b64 s[16:17], s[16:17], s[92:93]
    s_xor_b64 s[18:19], s[18:19], s[92:93]
    s_xor_b64 s[48:49], s[48:49], s[92:93]
    s_xor_b64 s[50:51], s[50:51], s[92:93]
    s_xor_b64 s[52:53], s[52:53], s[92:93]
    s_xor_b64 s[54:55], s[54:55], s[92:93]
    s_or_b64 s[12:13], s[12:13], s[14:15]
    s_or_b64 s[12:13], s[12:13], s[16:17]
    s_or_b64 s[12:13], s[12:13], s[18:19]
    s_or_b64 s[12:13], s[12:13], s[48:49]
    s_or_b64 s[12:13], s[12:13], s[50:51]
    s_or_b64 s[12:13], s[12:13], s[52:53]
    s_or_b64 s[12:13], s[12:13], s[54:55]
    s_cbranch_scc0 L_po_4
    s_sleep 2
    s_cmp_lt_u32 s91, 16
    s_cbranch_scc1 L_p_3
L_pv_6:
    buffer_load_dword v24, v21, s[44:47], s43 offen sc1
    s_waitcnt vmcnt(0)
    v_cmp_ne_u32 vcc, v24, v14
    s_cbranch_vccz L_po_4
    s_sub_u32 s90, s90, 1
    s_cmp_lt_i32 s90, 0
    s_cbranch_scc1 L_po_4
    s_add_u32 s91, s91, 1
    s_cmp_le_u32 s91, 32
    s_cbranch_scc1 L_pv_6
    s_lshl_b32 s34, s31, 3
    s_add_u32 s34, s34, s59
    s_lshl_b32 s34, s34, 11
    s_add_u32 s34, s34, 3801088
    v_readlane_b32 s35, v24, s30
    s_nop 0
    s_cmp_lg_u32 s35, s56
    s_cbranch_scc1 L_pn_5
    buffer_store_dword v14, v23, s[44:47], s34 offen sc1
L_pn_5:
    buffer_load_dword v24, v22, s[44:47], s34 offen sc1
    s_waitcnt vmcnt(0)
    v_cmp_ne_u32 vcc, v24, v14
    s_cbranch_vccnz L_pv_6
L_po_4:
    s_add_u32 s59, s59, 1
    s_add_u32 s43, s43, 1024
    s_mul_i32 s35, s37, 14336
    s_add_u32 m0, s42, 0
    s_add_u32 s37, s37, 1
    s_and_b32 s37, s37, 15
    buffer_load_dwordx4 v20, s[44:47], s35 offen offset:0 sc1 lds
    buffer_load_dwordx4 v20, s[44:47], s35 offen offset:1024 sc1 lds
    buffer_load_dwordx4 v20, s[44:47], s35 offen offset:2048 sc1 lds
    buffer_load_dwordx4 v20, s[44:47], s35 offen offset:3072 sc1 lds
    s_add_u32 m0, m0, 4096
    s_add_u32 s35, s35, 4096
    buffer_load_dwordx4 v20, s[44:47], s35 offen offset:0 sc1 lds
    buffer_load_dwordx4 v20, s[44:47], s35 offen offset:1024 sc1 lds
    buffer_load_dwordx4 v20, s[44:47], s35 offen offset:2048 sc1 lds
    s_mov_b32 m0, s57
    s_nop 0
    buffer_load_dword off, s[44:47], s58 sc1 lds
    s_add_u32 s58, s58, 4
    s_mul_i32 s35, s37, 14336
    s_add_u32 m0, s42, 30720
    s_add_u32 s37, s37, 1
    s_and_b32 s37, s37, 15
    buffer_load_dwordx4 v20, s[44:47], s35 offen offset:0 sc1 lds
    buffer_load_dwordx4 v20, s[44:47], s35 offen offset:1024 sc1 lds
    buffer_load_dwordx4 v20, s[44:47], s35 offen offset:2048 sc1 lds
    buffer_load_dwordx4 v20, s[44:47], s35 offen offset:3072 sc1 lds
    s_add_u32 m0, m0, 4096
    s_add_u32 s35, s35, 4096
    buffer_load_dwordx4 v20, s[44:47], s35 offen offset:0 sc1 lds
    buffer_load_dwordx4 v20, s[44:47], s35 offen offset:1024 sc1 lds
    buffer_load_dwordx4 v20, s[44:47], s35 offen offset:2048 sc1 lds
    s_mov_b32 m0, s57
    s_nop 0
    buffer_load_dword off, s[44:47], s58 sc1 lds
    s_add_u32 s58, s58, 4
    s_barrier
    s_mov_b32 s36, 61440
    s_mov_b32 s38, -1
L_lloop:
L_w_7:
    ds_read_b32 v11, v10
    s_waitcnt lgkmcnt(0)
    v_cmp_gt_i32 vcc, s38, v11
    s_cbranch_vccz L_wo_8
    s_sub_u32 s90, s90, 1
    s_cmp_lt_i32 s90, 0
    s_cbranch_scc1 L_wo_8
    s_sleep 2
    s_branch L_w_7
L_wo_8:
    s_waitcnt vmcnt(40)
    s_lshl_b32 s34, s32, 7
    s_add_u32 m0, s41, s36
    s_add_u32 s32, s32, 1
    s_and_b32 s32, s32, 15
    buffer_load_dwordx4 v16, s[8:11], s34 offen offset:0 lds
    buffer_load_dwordx4 v17, s[8:11], s34 offen offset:1024 lds
    buffer_load_dwordx4 v18, s[8:11], s34 offen offset:2048 lds
    buffer_load_dwordx4 v19, s[8:11], s34 offen offset:3072 lds
    s_add_u32 m0, m0, 4096
    s_add_u32 s34, s34, 65536
    buffer_load_dwordx4 v16, s[8:11], s34 offen offset:0 lds
    buffer_load_dwordx4 v17, s[8:11], s34 offen offset:1024 lds
    buffer_load_dwordx4 v18, s[8:11], s34 offen offset:2048 lds
    buffer_load_dwordx4 v19, s[8:11], s34 offen offset:3072 lds
    s_mov_b32 s91, 0
    s_mov_b32 s94, s43
L_p_9:
    s_load_dwordx8 s[12:19], s[22:23], s94
    s_load_dwordx8 s[48:55], s[22:23], s94 offset:32
    s_add_u32 s94, s94, 64
    s_add_u32 s91, s91, 1
    s_waitcnt lgkmcnt(0)
    s_xor_b64 s[12:13], s[12:13], s[92:93]
    s_xor_b64 s[14:15], s[14:15], s[92:93]
    s_xor_b64 s[16:17], s[16:17], s[92:93]
    s_xor_b64 s[18:19], s[18:19], s[92:93]
    s_xor_b64 s[48:49], s[48:49], s[92:93]
    s_xor_b64 s[50:51], s[50:51], s[92:93]
    s_xor_b64 s[52:53], s[52:53], s[92:93]
    s_xor_b64 s[54:55], s[54:55], s[92:93]
    s_or_b64 s[12:13], s[12:13], s[14:15]
    s_or_b64 s[12:13], s[12:13], s[16:17]
    s_or_b64 s[12:13], s[12:13], s[18:19]
    s_or_b64 s[12:13], s[12:13], s[48:49]
    s_or_b64 s[12:13], s[12:13], s[50:51]
    s_or_b64 s[12:13], s[12:13], s[52:53]
    s_or_b64 s[12:13], s[12:13], s[54:55]
    s_cbranch_scc0 L_po_10
    s_sleep 2
    s_cmp_lt_u32 s91, 16
    s_cbranch_scc1 L_p_9
L_pv_12:
    buffer_load_dword v24, v21, s[44:47], s43 offen sc1
    s_waitcnt vmcnt(0)
    v_cmp_ne_u32 vcc, v24, v14
    s_cbranch_vccz L_po_10
    s_sub_u32 s90, s90, 1
    s_cmp_lt_i32 s90, 0
    s_cbranch_scc1 L_po_10
    s_add_u32 s91, s91, 1
    s_cmp_le_u32 s91, 32
    s_cbranch_scc1 L_pv_12
    s_lshl_b32 s34, s31, 3
    s_add_u32 s34, s34, s59
    s_lshl_b32 s34, s34, 11
    s_add_u32 s34, s34, 3801088
    buffer_load_dword v24, v22, s[44:47], s34 offen sc1
    s_waitcnt vmcnt(0)
    v_cmp_ne_u32 vcc, v24, v14
    s_cbranch_vccnz L_pv_12
L_po_10:
    s_add_u32 s59, s59, 1
    s_add_u32 s43, s43, 1024
    s_mul_i32 s35, s37, 14336
    s_add_u32 m0, s42, s36
    s_add_u32 s37, s37, 1
    s_and_b32 s37, s37, 15
    buffer_load_dwordx4 v20, s[44:47], s35 offen offset:0 sc1 lds
    buffer_load_dwordx4 v20, s[44:47], s35 offen offset:1024 sc1 lds
    buffer_load_dwordx4 v20, s[44:47], s35 offen offset:2048 sc1 lds
    buffer_load_dwordx4 v20, s[44:47], s35 offen offset:3072 sc1 lds
    s_add_u32 m0, m0, 4096
    s_add_u32 s35, s35, 4096
    buffer_load_dwordx4 v20, s[44:47], s35 offen offset:0 sc1 lds
    buffer_load_dwordx4 v20, s[44:47], s35 offen offset:1024 sc1 lds
    buffer_load_dwordx4 v20, s[44:47], s35 offen offset:2048 sc1 lds
    s_mov_b32 m0, s57
    s_nop 0
    buffer_load_dword off, s[44:47], s58 sc1 lds
    s_add_u32 s58, s58, 4
    s_add_u32 s36, s36, 30720
    s_cmp_eq_u32 s36, 122880
    s_cselect_b32 s36, 0, s36
    s_add_u32 s38, s38, 1
    s_cmp_lg_u32 s38, 6
    s_cbranch_scc1 L_nr1
    s_lshl_b32 s29, s30, 4
    s_add_u32 s29, s29, s31
    s_lshl_b32 s29, s29, 1
    s_add_u32 s29, s29, s40
    s_lshl_b32 s35, s29, 13
    v_lshlrev_b32 v4, 4, v2
    s_waitcnt vmcnt(40)
    buffer_load_dwordx4 v[32:35], v4, s[8:11], s35 offen offset:0
    buffer_load_dwordx4 v[36:39], v4, s[8:11], s35 offen offset:1024
    buffer_load_dwordx4 v[40:43], v4, s[8:11], s35 offen offset:2048
    buffer_load_dwordx4 v[44:47], v4, s[8:11], s35 offen offset:3072
    s_add_u32 s35, s35, 4096
    buffer_load_dwordx4 v[48:51], v4, s[8:11], s35 offen offset:0
    buffer_load_dwordx4 v[52:55], v4, s[8:11], s35 offen offset:1024
    buffer_load_dwordx4 v[56:59], v4, s[8:11], s35 offen offset:2048
    buffer_load_dwordx4 v[60:63], v4, s[8:11], s35 offen offset:3072
L_nr1:
L_w_13:
    ds_read_b32 v11, v10
    s_waitcnt lgkmcnt(0)
    v_cmp_gt_i32 vcc, s38, v11
    s_cbranch_vccz L_wo_14
    s_sub_u32 s90, s90, 1
    s_cmp_lt_i32 s90, 0
    s_cbranch_scc1 L_wo_14
    s_sleep 2
    s_branch L_w_13
L_wo_14:
    s_waitcnt vmcnt(40)
    s_mul_i32 s35, s37, 14336
    s_add_u32 m0, s42, s36
    s_add_u32 s37, s37, 1
    s_and_b32 s37, s37, 15
    buffer_load_dwordx4 v20, s[44:47], s35 offen offset:0 sc1 lds
    buffer_load_dwordx4 v20, s[44:47], s35 offen offset:1024 sc1 lds
    buffer_load_dwordx4 v20, s[44:47], s35 offen offset:2048 sc1 lds
    buffer_load_dwordx4 v20, s[44:47], s35 offen offset:3072 sc1 lds
    s_add_u32 m0, m0, 4096
    s_add_u32 s35, s35, 4096
    buffer_load_dwordx4 v20, s[44:47], s35 offen offset:0 sc1 lds
    buffer_load_dwordx4 v20, s[44:47], s35 offen offset:1024 sc1 lds
    buffer_load_dwordx4 v20, s[44:47], s35 offen offset:2048 sc1 lds
    s_lshl_b32 s34, s32, 7
    s_add_u32 m0, s41, s36
    s_add_u32 s32, s32, 1
    s_and_b32 s32, s32, 15
    buffer_load_dwordx4 v16, s[8:11], s34 offen offset:0 lds
    buffer_load_dwordx4 v17, s[8:11], s34 offen offset:1024 lds
    buffer_load_dwordx4 v18, s[8:11], s34 offen offset:2048 lds
    buffer_load_dwordx4 v19, s[8:11], s34 offen offset:3072 lds
    s_add_u32 m0, m0, 4096
    s_add_u32 s34, s34, 65536
    buffer_load_dwordx4 v16, s[8:11], s34 offen offset:0 lds
    buffer_load_dwordx4 v17, s[8:11], s34 offen offset:1024 lds
    buffer_load_dwordx4 v18, s[8:11], s34 offen offset:2048 lds
    buffer_load_dwordx4 v19, s[8:11], s34 offen offset:3072 lds
    s_mov_b32 m0, s57
    s_nop 0
    buffer_load_dword off, s[44:47], s58 sc1 lds
    s_add_u32 s58, s58, 4
    s_add_u32 s36, s36, 30720
    s_cmp_eq_u32 s36, 122880
    s_cselect_b32 s36, 0, s36
    s_add_u32 s38, s38, 1
    s_cmp_lg_u32 s38, 7
    s_cbranch_scc1 L_nr2
    s_lshl_b32 s34, s29, 5
    s_add_u32 s34, s34, 4067328
    v_mov_b32 v81, s39
    v_mov_b32 v83, s39
    v_mov_b32 v85, s39
    v_mov_b32 v87, s39
    s_waitcnt vmcnt(16)
    s_setprio 2
    v_mfma_f32_16x16x32_bf16 v[64:67], v[28:31], v[32:35], 0
    v_mfma_f32_16x16x32_bf16 v[68:71], v[28:31], v[40:43], 0
    v_mfma_f32_16x16x32_bf16 v[72:75], v[28:31], v[48:51], 0
    v_mfma_f32_16x16x32_bf16 v[76:79], v[28:31], v[56:59], 0
    v_mfma_f32_16x16x32_bf16 v[64:67], v[28:31], v[36:39], v[64:67]
    v_mfma_f32_16x16x32_bf16 v[68:71], v[28:31], v[44:47], v[68:71]
    v_mfma_f32_16x16x32_bf16 v[72:75], v[28:31], v[52:55], v[72:75]
    v_mfma_f32_16x16x32_bf16 v[76:79], v[28:31], v[60:63], v[76:79]
    s_setprio 0
    s_nop 7
    v_add_f32_dpp v64, v64, v64 row_ror:8 row_mask:0xf bank_mask:0xf
    v_add_f32_dpp v68, v68, v68 row_ror:8 row_mask:0xf bank_mask:0xf
    v_add_f32_dpp v72, v72, v72 row_ror:8 row_mask:0xf bank_mask:0xf
    v_add_f32_dpp v76, v76, v76 row_ror:8 row_mask:0xf bank_mask:0xf
    v_add_f32_dpp v64, v64, v64 row_ror:4 row_mask:0xf bank_mask:0xf
    v_add_f32_dpp v68, v68, v68 row_ror:4 row_mask:0xf bank_mask:0xf
    v_add_f32_dpp v72, v72, v72 row_ror:4 row_mask:0xf bank_mask:0xf
    v_add_f32_dpp v76, v76, v76 row_ror:4 row_mask:0xf bank_mask:0xf
    v_add_f32_dpp v64, v64, v64 row_ror:2 row_mask:0xf bank_mask:0xf
    v_add_f32_dpp v68, v68, v68 row_ror:2 row_mask:0xf bank_mask:0xf
    v_add_f32_dpp v72, v72, v72 row_ror:2 row_mask:0xf bank_mask:0xf
    v_add_f32_dpp v76, v76, v76 row_ror:2 row_mask:0xf bank_mask:0xf
    v_add_f32_dpp v80, v64, v64 row_ror:1 row_mask:0xf bank_mask:0xf
    v_add_f32_dpp v82, v68, v68 row_ror:1 row_mask:0xf bank_mask:0xf
    v_add_f32_dpp v84, v72, v72 row_ror:1 row_mask:0xf bank_mask:0xf
    v_add_f32_dpp v86, v76, v76 row_ror:1 row_mask:0xf bank_mask:0xf
    buffer_store_dwordx4 v[80:83], v13, s[44:47], s34 offen sc1
    buffer_store_dwordx4 v[84:87], v13, s[44:47], s34 offen offset:16 sc1
L_nr2:
    s_cmp_lg_u32 s38, 13
    s_cbranch_scc1 L_lloop
    s_cmp_eq_u32 s40, 0
    s_cbranch_scc1 L_l0
    s_lshl_b32 s34, s30, 10
    s_add_u32 s34, s34, 4067328
    v_lshlrev_b32 v4, 4, v2
    v_lshrrev_b32 v5, 5, v2
    v_lshlrev_b32 v5, 8, v5
    v_and_b32 v6, 7, v2
    v_lshl_add_u32 v5, v6, 5, v5
    v_bfe_u32 v6, v2, 3, 2
    v_lshl_add_u32 v5, v6, 2, v5
    v_add_u32 v5, 156672, v5
    v_mov_b32 v6, 99
L_rsg:
    buffer_load_dwordx4 v[32:35], v4, s[44:47], s34 offen sc1
    s_waitcnt vmcnt(0)
    v_cmp_ne_u32 vcc, s39, v33
    v_cmp_ne_u32 s[48:49], s39, v35
    s_or_b64 vcc, vcc, s[48:49]
    s_cbranch_scc0 L_rso
    s_sub_u32 s90, s90, 1
    s_cmp_lt_i32 s90, 0
    s_cbranch_scc1 L_rso
    s_sleep 8
    s_branch L_rsg
L_rso:
    ds_write_b32 v5, v32
    ds_write_b32 v5, v34 offset:16
    ds_write_b32 v10, v6 offset:16
    s_cmp_lg_u32 s31, 0
    s_cbranch_scc1 L_help
    s_lshl_b32 s35, s30, 7
    s_add_u32 s35, s35, 4065280
    buffer_store_dword v81, v13, s[44:47], s35 offen sc1
    s_branch L_help
L_l0:
    s_cmp_lg_u32 s30, 0
    s_cbranch_scc1 L_help
    s_lshl_b32 s35, s31, 7
    s_add_u32 s35, s35, 4063232
    buffer_store_dword v14, v13, s[44:47], s35 offen sc1
    s_branch L_help
L_cons:
    s_and_b32 s40, s3, 1
    s_lshr_b32 s41, s3, 1
    v_and_b32 v3, 15, v2
    v_lshrrev_b32 v4, 4, v2
    s_lshl_b32 s34, s3, 2
    s_add_u32 s34, s34, 156160
    v_mov_b32 v14, s34
    v_mov_b32 v15, 0
    ds_write_b32 v14, v15
    ds_write_b32 v14, v15 offset:16
    ds_write_b32 v14, v15 offset:32
    v_and_b32 v5, 7, v2
    v_xor_b32 v5, v5, v4
    v_lshlrev_b32 v5, 4, v5
    v_lshl_add_u32 v5, v3, 7, v5
    s_lshl_b32 s34, s40, 13
    v_add_u32 v118, s34, v5
    v_xor_b32 v119, 64, v118
    s_lshl_b32 s39, s3, 13
    s_add_u32 s39, s39, 122880
    v_add_u32 v0, s39, v5
    v_xor_b32 v1, 64, v0
    v_mul_u32_u24 v6, 1792, v4
    v_add_u32 v6, 16384, v6
    v_and_b32 v5, 1, v2
    v_mul_u32_u24 v7, 896, v5
    v_lshrrev_b32 v8, 1, v3
    v_lshlrev_b32 v8, 4, v8
    v_add3_u32 v7, v7, v8, v6
    s_mul_i32 s34, s41, 384
    v_add_u32 v120, s34, v7
    v_mul_u32_u24 v12, 260, v5
    v_add_u32 v12, 155648, v12
    v_lshl_add_u32 v6, v5, 3, v6
    v_bfe_u32 v5, v2, 1, 1
    v_mul_u32_u24 v5, 896, v5
    v_lshrrev_b32 v7, 2, v3
    v_lshlrev_b32 v7, 5, v7
    v_add3_u32 v6, v6, v5, v7
    s_lshl_b32 s34, s41, 4
    s_add_u32 s34, s34, 768
    v_add_u32 v121, s34, v6
    v_lshlrev_b32 v8, 4, v4
    s_waitcnt lgkmcnt(0)
    s_mov_b32 s48, s16
    s_mov_b32 s49, s17
    s_mov_b32 s50, 7168
    s_mov_b32 s51, 0x00020000
    s_mov_b32 s52, s18
    s_mov_b32 s53, s19
    s_mov_b32 s54, 7168
    s_mov_b32 s55, 0x00020000
    s_mov_b32 s24, s20
    s_mov_b32 s25, s21
    s_mov_b32 s26, 14680064
    s_mov_b32 s27, 0x00020000
    s_cmp_lg_u32 s40, 0
    s_cbranch_scc1 L_c1
    s_mul_i32 s34, s31, 448
    s_mul_i32 s35, s41, 192
    s_add_u32 s35, s35, s34
    buffer_load_dwordx4 v[16:19], v8, s[48:51], s35 offen offset:0
    buffer_load_dwordx4 v[32:35], v8, s[52:55], s35 offen offset:0
    buffer_load_dwordx4 v[20:23], v8, s[48:51], s35 offen offset:64
    buffer_load_dwordx4 v[36:39], v8, s[52:55], s35 offen offset:64
    buffer_load_dwordx4 v[24:27], v8, s[48:51], s35 offen offset:128
    buffer_load_dwordx4 v[40:43], v8, s[52:55], s35 offen offset:128
    s_lshl_b32 s35, s41, 3
    s_add_u32 s35, s35, s34
    buffer_load_dwordx2 v[28:29], v8, s[48:51], s35 offen offset:384
    buffer_load_dwordx2 v[44:45], v8, s[52:55], s35 offen offset:384
L_c1:
    s_mul_i32 s34, s41, 448
    s_add_u32 s34, s34, 157184
    v_add_u32 v241, s34, v8
    s_lshl_b32 s34, s40, 8
    s_add_u32 s34, s34, 156672
    v_lshl_add_u32 v242, v3, 4, s34
    v_lshrrev_b32 v5, 1, v3
    v_and_b32 v5, 3, v5
    v_xor_b32 v5, v5, v4
    v_lshlrev_b32 v5, 4, v5
    v_mul_u32_u24 v6, 192, v3
    s_mul_i32 s34, s40, 12288
    v_add3_u32 v5, v5, v6, s34
    s_lshl_b32 s34, s41, 6
    v_add_u32 v6, s34, v5
    s_lshl_b32 s34, s41, 3
    v_add_u32 v7, s34, v5
    v_lshrrev_b32 v8, 3, v2
    v_and_b32 v9, 7, v2
    v_xor_b32 v3, v8, v9
    v_lshlrev_b32 v3, 4, v3
    v_lshl_add_u32 v3, v8, 7, v3
    v_add_u32 v3, s39, v3
    s_lshl_b32 s34, s30, 7
    s_lshl_b32 s35, s40, 6
    s_add_u32 s34, s34, s35
    v_add_u32 v8, s34, v8
    v_mul_u32_u24 v8, 7168, v8
    v_lshl_add_u32 v8, v9, 4, v8
    s_mul_i32 s34, s31, 448
    s_mul_i32 s35, s41, 192
    s_add_u32 s34, s34, s35
    v_add_u32 v4, s34, v8
    v_lshlrev_b32 v5, 2, v9
    v_add_u32 v5, 156160, v5
    v_mov_b32 v240, 1128481603
    s_mov_b32 s42, 0x04010400
    s_mov_b32 s43, 0x04030402
    s_mov_b32 s36, 0
    s_mov_b32 s38, 2
    v_mov_b32 v8, v118
    v_mov_b32 v9, v119
    v_mov_b32 v10, v120
    v_mov_b32 v11, v121
    v_mov_b32 v128, 0
    v_mov_b32 v129, 0
    v_mov_b32 v130, 0
    v_mov_b32 v131, 0
    v_mov_b32 v132, 0
    v_mov_b32 v133, 0
    v_mov_b32 v134, 0
    v_mov_b32 v135, 0
    v_mov_b32 v136, 0
    v_mov_b32 v137, 0
    v_mov_b32 v138, 0
    v_mov_b32 v139, 0
    v_mov_b32 v140, 0
    v_mov_b32 v141, 0
    v_mov_b32 v142, 0
    v_mov_b32 v143, 0
    v_mov_b32 v144, 0
    v_mov_b32 v145, 0
    v_mov_b32 v146, 0
    v_mov_b32 v147, 0
    v_mov_b32 v148, 0
    v_mov_b32 v149, 0
    v_mov_b32 v150, 0
    v_mov_b32 v151, 0
    v_mov_b32 v152, 0
    v_mov_b32 v153, 0
    v_mov_b32 v154, 0
    v_mov_b32 v155, 0
    v_mov_b32 v156, 0
    v_mov_b32 v157, 0
    v_mov_b32 v158, 0
    v_mov_b32 v159, 0
    v_mov_b32 v160, 0
    v_mov_b32 v161, 0
    v_mov_b32 v162, 0
    v_mov_b32 v163, 0
    v_mov_b32 v164, 0
    v_mov_b32 v165, 0
    v_mov_b32 v166, 0
    v_mov_b32 v167, 0
    v_mov_b32 v168, 0
    v_mov_b32 v169, 0
    v_mov_b32 v170, 0
    v_mov_b32 v171, 0
    v_mov_b32 v172, 0
    v_mov_b32 v173, 0
    v_mov_b32 v174, 0
    v_mov_b32 v175, 0
    v_mov_b32 v176, 0
    v_mov_b32 v177, 0
    v_mov_b32 v178, 0
    v_mov_b32 v179, 0
    v_mov_b32 v180, 0
    v_mov_b32 v181, 0
    v_mov_b32 v182, 0
    v_mov_b32 v183, 0
    v_mov_b32 v184, 0
    v_mov_b32 v185, 0
    v_mov_b32 v186, 0
    v_mov_b32 v187, 0
    v_mov_b32 v188, 0
    v_mov_b32 v189, 0
    v_mov_b32 v190, 0
    v_mov_b32 v191, 0
    v_mov_b32 v192, 0
    v_mov_b32 v193, 0
    v_mov_b32 v194, 0
    v_mov_b32 v195, 0
    v_mov_b32 v196, 0
    v_mov_b32 v197, 0
    v_mov_b32 v198, 0
    v_mov_b32 v199, 0
    v_mov_b32 v200, 0
    v_mov_b32 v201, 0
    v_mov_b32 v202, 0
    v_mov_b32 v203, 0
    v_mov_b32 v204, 0
    v_mov_b32 v205, 0
    v_mov_b32 v206, 0
    v_mov_b32 v207, 0
    v_mov_b32 v208, 0
    v_mov_b32 v209, 0
    v_mov_b32 v210, 0
    v_mov_b32 v211, 0
    v_mov_b32 v212, 0
    v_mov_b32 v213, 0
    v_mov_b32 v214, 0
    v_mov_b32 v215, 0
    v_mov_b32 v216, 0
    v_mov_b32 v217, 0
    v_mov_b32 v218, 0
    v_mov_b32 v219, 0
    v_mov_b32 v220, 0
    v_mov_b32 v221, 0
    v_mov_b32 v222, 0
    v_mov_b32 v223, 0
    v_mov_b32 v224, 0
    v_mov_b32 v225, 0
    v_mov_b32 v226, 0
    v_mov_b32 v227, 0
    v_mov_b32 v228, 0
    v_mov_b32 v229, 0
    v_mov_b32 v230, 0
    v_mov_b32 v231, 0
    v_mov_b32 v232, 0
    v_mov_b32 v233, 0
    v_mov_b32 v234, 0
    v_mov_b32 v235, 0
    v_mov_b32 v236, 0
    v_mov_b32 v237, 0
    v_mov_b32 v238, 0
    v_mov_b32 v239, 0
    s_mov_b64 exec, 0
    s_branch L_epi
L_dryret:
    s_mov_b64 exec, -1
    s_waitcnt lgkmcnt(0)
    s_barrier
    s_cmp_lg_u32 s40, 0
    s_cbranch_scc1 L_c2
    s_waitcnt vmcnt(0)
    s_mov_b32 s34, 3271557120
    v_lshlrev_b32 v64, 16, v16
    v_lshlrev_b32 v65, 16, v17
    v_lshlrev_b32 v66, 16, v18
    v_lshlrev_b32 v67, 16, v19
    ds_write_b128 v241, v[64:67] offset:0
    v_lshlrev_b32 v72, 16, v32
    v_lshlrev_b32 v73, 16, v33
    v_lshlrev_b32 v74, 16, v34
    v_lshlrev_b32 v75, 16, v35
    v_sub_f32 v72, s34, v72
    v_sub_f32 v73, s34, v73
    v_sub_f32 v74, s34, v74
    v_sub_f32 v75, s34, v75
    ds_write_b128 v241, v[72:75] offset:896
    v_and_b32 v80, 0xffff0000, v16
    v_and_b32 v81, 0xffff0000, v17
    v_and_b32 v82, 0xffff0000, v18
    v_and_b32 v83, 0xffff0000, v19
    ds_write_b128 v241, v[80:83] offset:64
    v_and_b32 v88, 0xffff0000, v32
    v_and_b32 v89, 0xffff0000, v33
    v_and_b32 v90, 0xffff0000, v34
    v_and_b32 v91, 0xffff0000, v35
    v_sub_f32 v88, s34, v88
    v_sub_f32 v89, s34, v89
    v_sub_f32 v90, s34, v90
    v_sub_f32 v91, s34, v91
    ds_write_b128 v241, v[88:91] offset:960
    v_lshlrev_b32 v64, 16, v20
    v_lshlrev_b32 v65, 16, v21
    v_lshlrev_b32 v66, 16, v22
    v_lshlrev_b32 v67, 16, v23
    ds_write_b128 v241, v[64:67] offset:128
    v_lshlrev_b32 v72, 16, v36
    v_lshlrev_b32 v73, 16, v37
    v_lshlrev_b32 v74, 16, v38
    v_lshlrev_b32 v75, 16, v39
    v_sub_f32 v72, s34, v72
    v_sub_f32 v73, s34, v73
    v_sub_f32 v74, s34, v74
    v_sub_f32 v75, s34, v75
    ds_write_b128 v241, v[72:75] offset:1024
    v_and_b32 v80, 0xffff0000, v20
    v_and_b32 v81, 0xffff0000, v21
    v_and_b32 v82, 0xffff0000, v22
    v_and_b32 v83, 0xffff0000, v23
    ds_write_b128 v241, v[80:83] offset:192
    v_and_b32 v88, 0xffff0000, v36
    v_and_b32 v89, 0xffff0000, v37
    v_and_b32 v90, 0xffff0000, v38
    v_and_b32 v91, 0xffff0000, v39
    v_sub_f32 v88, s34, v88
    v_sub_f32 v89, s34, v89
    v_sub_f32 v90, s34, v90
    v_sub_f32 v91, s34, v91
    ds_write_b128 v241, v[88:91] offset:1088
    v_lshlrev_b32 v64, 16, v24
    v_lshlrev_b32 v65, 16, v25
    v_lshlrev_b32 v66, 16, v26
    v_lshlrev_b32 v67, 16, v27
    ds_write_b128 v241, v[64:67] offset:256
    v_lshlrev_b32 v72, 16, v40
    v_lshlrev_b32 v73, 16, v41
    v_lshlrev_b32 v74, 16, v42
    v_lshlrev_b32 v75, 16, v43
    v_sub_f32 v72, s34, v72
    v_sub_f32 v73, s34, v73
    v_sub_f32 v74, s34, v74
    v_sub_f32 v75, s34, v75
    ds_write_b128 v241, v[72:75] offset:1152
    v_and_b32 v80, 0xffff0000, v24
    v_and_b32 v81, 0xffff0000, v25
    v_and_b32 v82, 0xffff0000, v26
    v_and_b32 v83, 0xffff0000, v27
    ds_write_b128 v241, v[80:83] offset:320
    v_and_b32 v88, 0xffff0000, v40
    v_and_b32 v89, 0xffff0000, v41
    v_and_b32 v90, 0xffff0000, v42
    v_and_b32 v91, 0xffff0000, v43
    v_sub_f32 v88, s34, v88
    v_sub_f32 v89, s34, v89
    v_sub_f32 v90, s34, v90
    v_sub_f32 v91, s34, v91
    ds_write_b128 v241, v[88:91] offset:1216
    v_lshlrev_b32 v64, 16, v28
    v_and_b32 v65, 0xffff0000, v28
    v_lshlrev_b32 v66, 16, v29
    v_and_b32 v67, 0xffff0000, v29
    ds_write_b128 v241, v[64:67] offset:384
    v_lshlrev_b32 v72, 16, v44
    v_and_b32 v73, 0xffff0000, v44
    v_lshlrev_b32 v74, 16, v45
    v_and_b32 v75, 0xffff0000, v45
    v_sub_f32 v72, s34, v72
    v_sub_f32 v73, s34, v73
    v_sub_f32 v74, s34, v74
    v_sub_f32 v75, s34, v75
    ds_write_b128 v241, v[72:75] offset:1280
L_c2:
    s_barrier
L_w_15:
    ds_read_b32 v13, v12
    s_waitcnt lgkmcnt(0)
    v_cmp_gt_i32 vcc, 1, v13
    s_cbranch_vccz L_wo_16
    s_sub_u32 s90, s90, 1
    s_cmp_lt_i32 s90, 0
    s_cbranch_scc1 L_wo_16
    s_branch L_w_15
L_wo_16:
    ds_read_b128 v[60:63], v10 offset:0
    ds_read_b128 v[108:111], v10 offset:128
    ds_read_b128 v[112:115], v10 offset:256
    ds_read_b64 v[116:117], v11 offset:0
    ds_read_b128 v[16:19], v8 offset:0
    ds_read_b128 v[20:23], v8 offset:2048
    ds_read_b128 v[24:27], v8 offset:4096
    ds_read_b128 v[28:31], v8 offset:6144
    s_waitcnt lgkmcnt(4)
    v_perm_b32 v32, v240, v60, s42
    v_perm_b32 v33, v240, v60, s43
    v_perm_b32 v34, v240, v61, s42
    v_perm_b32 v35, v240, v61, s43
    v_perm_b32 v36, v240, v62, s42
    v_perm_b32 v37, v240, v62, s43
    v_perm_b32 v38, v240, v63, s42
    v_perm_b32 v39, v240, v63, s43
    v_perm_b32 v40, v240, v108, s42
    v_perm_b32 v41, v240, v108, s43
    v_perm_b32 v42, v240, v109, s42
    v_perm_b32 v43, v240, v109, s43
    v_perm_b32 v44, v240, v110, s42
    v_perm_b32 v45, v240, v110, s43
    v_perm_b32 v46, v240, v111, s42
    v_perm_b32 v47, v240, v111, s43
    v_perm_b32 v48, v240, v112, s42
    v_perm_b32 v49, v240, v112, s43
    v_perm_b32 v50, v240, v113, s42
    v_perm_b32 v51, v240, v113, s43
    v_perm_b32 v52, v240, v114, s42
    v_perm_b32 v53, v240, v114, s43
    v_perm_b32 v54, v240, v115, s42
    v_perm_b32 v55, v240, v115, s43
    v_perm_b32 v56, v240, v116, s42
    v_perm_b32 v57, v240, v116, s43
    v_perm_b32 v58, v240, v117, s42
    v_perm_b32 v59, v240, v117, s43
    s_waitcnt lgkmcnt(0)
.p2align 6
L_cloop:
    v_mfma_f32_16x16x32_bf16 v[128:131], v[32:35], v[16:19], v[128:131]
    ds_read_b128 v[60:63], v10 offset:7168
    v_mfma_f32_16x16x32_bf16 v[132:135], v[36:39], v[16:19], v[132:135]
    ds_read_b128 v[108:111], v10 offset:7296
    v_mfma_f32_16x16x32_bf16 v[136:139], v[40:43], v[16:19], v[136:139]
    ds_read_b128 v[112:115], v10 offset:7424
    v_mfma_f32_16x16x32_bf16 v[140:143], v[44:47], v[16:19], v[140:143]
    ds_read_b64 v[116:117], v11 offset:7168
    v_mfma_f32_16x16x32_bf16 v[144:147], v[48:51], v[16:19], v[144:147]
    ds_read_b128 v[64:67], v9 offset:0
    v_mfma_f32_16x16x32_bf16 v[148:151], v[52:55], v[16:19], v[148:151]
    ds_read_b128 v[68:71], v9 offset:2048
    s_add_u32 s36, s36, 30720
    v_mfma_f32_16x16x32_bf16 v[152:155], v[56:59], v[16:19], v[152:155]
    ds_read_b128 v[72:75], v9 offset:4096
    s_cmp_eq_u32 s36, 122880
    v_mfma_f32_16x16x32_bf16 v[180:183], v[56:59], v[20:23], v[180:183]
    ds_read_b128 v[76:79], v9 offset:6144
    s_cselect_b32 s36, 0, s36
    v_mfma_f32_16x16x32_bf16 v[176:179], v[52:55], v[20:23], v[176:179]
    v_add_u32 v8, s36, v118
    v_add_u32 v10, s36, v120
    v_mfma_f32_16x16x32_bf16 v[172:175], v[48:51], v[20:23], v[172:175]
    v_add_u32 v11, s36, v121
    s_waitcnt lgkmcnt(6)
    v_mfma_f32_16x16x32_bf16 v[168:171], v[44:47], v[20:23], v[168:171]
    v_perm_b32 v80, v240, v60, s42
    v_perm_b32 v81, v240, v60, s43
    v_mfma_f32_16x16x32_bf16 v[164:167], v[40:43], v[20:23], v[164:167]
    v_perm_b32 v82, v240, v61, s42
    v_perm_b32 v83, v240, v61, s43
    v_mfma_f32_16x16x32_bf16 v[160:163], v[36:39], v[20:23], v[160:163]
    v_perm_b32 v84, v240, v62, s42
    v_perm_b32 v85, v240, v62, s43
    v_mfma_f32_16x16x32_bf16 v[156:159], v[32:35], v[20:23], v[156:159]
    v_perm_b32 v86, v240, v63, s42
    v_perm_b32 v87, v240, v63, s43
    v_mfma_f32_16x16x32_bf16 v[184:187], v[32:35], v[24:27], v[184:187]
    v_perm_b32 v88, v240, v108, s42
    v_perm_b32 v89, v240, v108, s43
    v_mfma_f32_16x16x32_bf16 v[188:191], v[36:39], v[24:27], v[188:191]
    v_perm_b32 v90, v240, v109, s42
    v_perm_b32 v91, v240, v109, s43
    v_mfma_f32_16x16x32_bf16 v[192:195], v[40:43], v[24:27], v[192:195]
    v_perm_b32 v92, v240, v110, s42
    v_perm_b32 v93, v240, v110, s43
    v_mfma_f32_16x16x32_bf16 v[196:199], v[44:47], v[24:27], v[196:199]
    v_perm_b32 v94, v240, v111, s42
    v_perm_b32 v95, v240, v111, s43
    v_mfma_f32_16x16x32_bf16 v[200:203], v[48:51], v[24:27], v[200:203]
    ds_read_b32 v13, v12
    s_waitcnt lgkmcnt(1)
    v_mfma_f32_16x16x32_bf16 v[204:207], v[52:55], v[24:27], v[204:207]
    v_perm_b32 v96, v240, v112, s42
    v_perm_b32 v97, v240, v112, s43
    v_mfma_f32_16x16x32_bf16 v[208:211], v[56:59], v[24:27], v[208:211]
    v_perm_b32 v98, v240, v113, s42
    v_perm_b32 v99, v240, v113, s43
    v_mfma_f32_16x16x32_bf16 v[236:239], v[56:59], v[28:31], v[236:239]
    v_perm_b32 v100, v240, v114, s42
    v_perm_b32 v101, v240, v114, s43
    v_mfma_f32_16x16x32_bf16 v[232:235], v[52:55], v[28:31], v[232:235]
    v_perm_b32 v102, v240, v115, s42
    v_perm_b32 v103, v240, v115, s43
    v_mfma_f32_16x16x32_bf16 v[228:231], v[48:51], v[28:31], v[228:231]
    v_perm_b32 v104, v240, v116, s42
    v_perm_b32 v105, v240, v116, s43
    v_mfma_f32_16x16x32_bf16 v[224:227], v[44:47], v[28:31], v[224:227]
    v_perm_b32 v106, v240, v117, s42
    v_perm_b32 v107, v240, v117, s43
    v_mfma_f32_16x16x32_bf16 v[220:223], v[40:43], v[28:31], v[220:223]
    v_mfma_f32_16x16x32_bf16 v[216:219], v[36:39], v[28:31], v[216:219]
    s_waitcnt lgkmcnt(0)
    v_cmp_gt_i32 vcc, s38, v13
    v_mfma_f32_16x16x32_bf16 v[212:215], v[32:35], v[28:31], v[212:215]
    s_cbranch_vccnz L_fs_17
L_fb_18:
    v_mfma_f32_16x16x32_bf16 v[128:131], v[80:83], v[64:67], v[128:131]
    ds_read_b128 v[60:63], v10 offset:0
    v_mfma_f32_16x16x32_bf16 v[132:135], v[84:87], v[64:67], v[132:135]
    ds_read_b128 v[108:111], v10 offset:128
    v_mfma_f32_16x16x32_bf16 v[136:139], v[88:91], v[64:67], v[136:139]
    ds_read_b128 v[112:115], v10 offset:256
    v_mfma_f32_16x16x32_bf16 v[140:143], v[92:95], v[64:67], v[140:143]
    ds_read_b64 v[116:117], v11 offset:0
    v_mfma_f32_16x16x32_bf16 v[144:147], v[96:99], v[64:67], v[144:147]
    ds_read_b128 v[16:19], v8 offset:0
    v_mfma_f32_16x16x32_bf16 v[148:151], v[100:103], v[64:67], v[148:151]
    ds_read_b128 v[20:23], v8 offset:2048
    v_mfma_f32_16x16x32_bf16 v[152:155], v[104:107], v[64:67], v[152:155]
    ds_read_b128 v[24:27], v8 offset:4096
    v_mfma_f32_16x16x32_bf16 v[180:183], v[104:107], v[68:71], v[180:183]
    ds_read_b128 v[28:31], v8 offset:6144
    v_mfma_f32_16x16x32_bf16 v[176:179], v[100:103], v[68:71], v[176:179]
    v_add_u32 v9, s36, v119
    v_add_u32 v15, 1, v15
    v_mfma_f32_16x16x32_bf16 v[172:175], v[96:99], v[68:71], v[172:175]
    ds_write_b32 v14, v15
    v_mfma_f32_16x16x32_bf16 v[168:171], v[92:95], v[68:71], v[168:171]
    s_waitcnt lgkmcnt(8)
    v_perm_b32 v32, v240, v60, s42
    v_mfma_f32_16x16x32_bf16 v[164:167], v[88:91], v[68:71], v[164:167]
    v_perm_b32 v33, v240, v60, s43
    v_perm_b32 v34, v240, v61, s42
    v_mfma_f32_16x16x32_bf16 v[160:163], v[84:87], v[68:71], v[160:163]
    v_perm_b32 v35, v240, v61, s43
    v_perm_b32 v36, v240, v62, s42
    v_mfma_f32_16x16x32_bf16 v[156:159], v[80:83], v[68:71], v[156:159]
    v_perm_b32 v37, v240, v62, s43
    v_perm_b32 v38, v240, v63, s42
    v_mfma_f32_16x16x32_bf16 v[184:187], v[80:83], v[72:75], v[184:187]
    v_perm_b32 v39, v240, v63, s43
    s_waitcnt lgkmcnt(5)
    v_mfma_f32_16x16x32_bf16 v[188:191], v[84:87], v[72:75], v[188:191]
    v_perm_b32 v40, v240, v108, s42
    v_perm_b32 v41, v240, v108, s43
    v_mfma_f32_16x16x32_bf16 v[192:195], v[88:91], v[72:75], v[192:195]
    v_perm_b32 v42, v240, v109, s42
    v_perm_b32 v43, v240, v109, s43
    v_mfma_f32_16x16x32_bf16 v[196:199], v[92:95], v[72:75], v[196:199]
    v_perm_b32 v44, v240, v110, s42
    v_perm_b32 v45, v240, v110, s43
    v_mfma_f32_16x16x32_bf16 v[200:203], v[96:99], v[72:75], v[200:203]
    v_perm_b32 v46, v240, v111, s42
    v_perm_b32 v47, v240, v111, s43
    v_mfma_f32_16x16x32_bf16 v[204:207], v[100:103], v[72:75], v[204:207]
    v_perm_b32 v48, v240, v112, s42
    v_perm_b32 v49, v240, v112, s43
    v_mfma_f32_16x16x32_bf16 v[208:211], v[104:107], v[72:75], v[208:211]
    v_perm_b32 v50, v240, v113, s42
    v_perm_b32 v51, v240, v113, s43
    v_mfma_f32_16x16x32_bf16 v[236:239], v[104:107], v[76:79], v[236:239]
    v_perm_b32 v52, v240, v114, s42
    v_perm_b32 v53, v240, v114, s43
    v_mfma_f32_16x16x32_bf16 v[232:235], v[100:103], v[76:79], v[232:235]
    v_perm_b32 v54, v240, v115, s42
    v_perm_b32 v55, v240, v115, s43
    v_mfma_f32_16x16x32_bf16 v[228:231], v[96:99], v[76:79], v[228:231]
    v_perm_b32 v56, v240, v116, s42
    v_perm_b32 v57, v240, v116, s43
    v_mfma_f32_16x16x32_bf16 v[224:227], v[92:95], v[76:79], v[224:227]
    v_perm_b32 v58, v240, v117, s42
    v_perm_b32 v59, v240, v117, s43
    s_waitcnt lgkmcnt(0)
    v_mfma_f32_16x16x32_bf16 v[220:223], v[88:91], v[76:79], v[220:223]
    s_add_u32 s38, s38, 1
    s_cmp_lg_u32 s38, 14
    v_mfma_f32_16x16x32_bf16 v[216:219], v[84:87], v[76:79], v[216:219]
    v_mfma_f32_16x16x32_bf16 v[212:215], v[80:83], v[76:79], v[212:215]
    s_cbranch_scc1 L_cloop
L_tail:
    v_mfma_f32_16x16x32_bf16 v[128:131], v[32:35], v[16:19], v[128:131]
    ds_read_b128 v[60:63], v10 offset:7168
    v_mfma_f32_16x16x32_bf16 v[132:135], v[36:39], v[16:19], v[132:135]
    ds_read_b128 v[108:111], v10 offset:7296
    v_mfma_f32_16x16x32_bf16 v[136:139], v[40:43], v[16:19], v[136:139]
    ds_read_b128 v[112:115], v10 offset:7424
    v_mfma_f32_16x16x32_bf16 v[140:143], v[44:47], v[16:19], v[140:143]
    ds_read_b64 v[116:117], v11 offset:7168
    v_mfma_f32_16x16x32_bf16 v[144:147], v[48:51], v[16:19], v[144:147]
    ds_read_b128 v[64:67], v9 offset:0
    v_mfma_f32_16x16x32_bf16 v[148:151], v[52:55], v[16:19], v[148:151]
    ds_read_b128 v[68:71], v9 offset:2048
    s_add_u32 s36, s36, 30720
    v_mfma_f32_16x16x32_bf16 v[152:155], v[56:59], v[16:19], v[152:155]
    ds_read_b128 v[72:75], v9 offset:4096
    s_cmp_eq_u32 s36, 122880
    v_mfma_f32_16x16x32_bf16 v[180:183], v[56:59], v[20:23], v[180:183]
    ds_read_b128 v[76:79], v9 offset:6144
    s_cselect_b32 s36, 0, s36
    v_mfma_f32_16x16x32_bf16 v[176:179], v[52:55], v[20:23], v[176:179]
    v_add_u32 v8, s36, v118
    v_add_u32 v10, s36, v120
    v_mfma_f32_16x16x32_bf16 v[172:175], v[48:51], v[20:23], v[172:175]
    v_add_u32 v11, s36, v121
    s_waitcnt lgkmcnt(6)
    v_mfma_f32_16x16x32_bf16 v[168:171], v[44:47], v[20:23], v[168:171]
    v_perm_b32 v80, v240, v60, s42
    v_perm_b32 v81, v240, v60, s43
    v_mfma_f32_16x16x32_bf16 v[164:167], v[40:43], v[20:23], v[164:167]
    v_perm_b32 v82, v240, v61, s42
    v_perm_b32 v83, v240, v61, s43
    v_mfma_f32_16x16x32_bf16 v[160:163], v[36:39], v[20:23], v[160:163]
    v_perm_b32 v84, v240, v62, s42
    v_perm_b32 v85, v240, v62, s43
    v_mfma_f32_16x16x32_bf16 v[156:159], v[32:35], v[20:23], v[156:159]
    v_perm_b32 v86, v240, v63, s42
    v_perm_b32 v87, v240, v63, s43
    v_mfma_f32_16x16x32_bf16 v[184:187], v[32:35], v[24:27], v[184:187]
    v_perm_b32 v88, v240, v108, s42
    v_perm_b32 v89, v240, v108, s43
    v_mfma_f32_16x16x32_bf16 v[188:191], v[36:39], v[24:27], v[188:191]
    v_perm_b32 v90, v240, v109, s42
    v_perm_b32 v91, v240, v109, s43
    v_mfma_f32_16x16x32_bf16 v[192:195], v[40:43], v[24:27], v[192:195]
    v_perm_b32 v92, v240, v110, s42
    v_perm_b32 v93, v240, v110, s43
    v_mfma_f32_16x16x32_bf16 v[196:199], v[44:47], v[24:27], v[196:199]
    v_perm_b32 v94, v240, v111, s42
    v_perm_b32 v95, v240, v111, s43
    v_mfma_f32_16x16x32_bf16 v[200:203], v[48:51], v[24:27], v[200:203]
    ds_read_b32 v13, v12
    s_waitcnt lgkmcnt(1)
    v_mfma_f32_16x16x32_bf16 v[204:207], v[52:55], v[24:27], v[204:207]
    v_perm_b32 v96, v240, v112, s42
    v_perm_b32 v97, v240, v112, s43
    v_mfma_f32_16x16x32_bf16 v[208:211], v[56:59], v[24:27], v[208:211]
    v_perm_b32 v98, v240, v113, s42
    v_perm_b32 v99, v240, v113, s43
    v_mfma_f32_16x16x32_bf16 v[236:239], v[56:59], v[28:31], v[236:239]
    v_perm_b32 v100, v240, v114, s42
    v_perm_b32 v101, v240, v114, s43
    v_mfma_f32_16x16x32_bf16 v[232:235], v[52:55], v[28:31], v[232:235]
    v_perm_b32 v102, v240, v115, s42
    v_perm_b32 v103, v240, v115, s43
    v_mfma_f32_16x16x32_bf16 v[228:231], v[48:51], v[28:31], v[228:231]
    v_perm_b32 v104, v240, v116, s42
    v_perm_b32 v105, v240, v116, s43
    v_mfma_f32_16x16x32_bf16 v[224:227], v[44:47], v[28:31], v[224:227]
    v_perm_b32 v106, v240, v117, s42
    v_perm_b32 v107, v240, v117, s43
    v_mfma_f32_16x16x32_bf16 v[220:223], v[40:43], v[28:31], v[220:223]
    v_mfma_f32_16x16x32_bf16 v[216:219], v[36:39], v[28:31], v[216:219]
    s_waitcnt lgkmcnt(0)
    v_cmp_gt_i32 vcc, s38, v13
    v_mfma_f32_16x16x32_bf16 v[212:215], v[32:35], v[28:31], v[212:215]
    s_cbranch_vccnz L_fs_19
L_fb_20:
    v_mfma_f32_16x16x32_bf16 v[128:131], v[80:83], v[64:67], v[128:131]
    ds_read_b128 v[60:63], v10 offset:0
    v_mfma_f32_16x16x32_bf16 v[132:135], v[84:87], v[64:67], v[132:135]
    ds_read_b128 v[108:111], v10 offset:128
    v_mfma_f32_16x16x32_bf16 v[136:139], v[88:91], v[64:67], v[136:139]
    ds_read_b128 v[112:115], v10 offset:256
    v_mfma_f32_16x16x32_bf16 v[140:143], v[92:95], v[64:67], v[140:143]
    ds_read_b64 v[116:117], v11 offset:0
    v_mfma_f32_16x16x32_bf16 v[144:147], v[96:99], v[64:67], v[144:147]
    ds_read_b128 v[16:19], v8 offset:0
    v_mfma_f32_16x16x32_bf16 v[148:151], v[100:103], v[64:67], v[148:151]
    ds_read_b128 v[20:23], v8 offset:2048
    v_mfma_f32_16x16x32_bf16 v[152:155], v[104:107], v[64:67], v[152:155]
    ds_read_b128 v[24:27], v8 offset:4096
    v_mfma_f32_16x16x32_bf16 v[180:183], v[104:107], v[68:71], v[180:183]
    ds_read_b128 v[28:31], v8 offset:6144
    v_mfma_f32_16x16x32_bf16 v[176:179], v[100:103], v[68:71], v[176:179]
    v_add_u32 v9, s36, v119
    v_add_u32 v15, 1, v15
    v_mfma_f32_16x16x32_bf16 v[172:175], v[96:99], v[68:71], v[172:175]
    ds_write_b32 v14, v15
    v_mfma_f32_16x16x32_bf16 v[168:171], v[92:95], v[68:71], v[168:171]
    s_waitcnt lgkmcnt(8)
    v_perm_b32 v32, v240, v60, s42
    v_mfma_f32_16x16x32_bf16 v[164:167], v[88:91], v[68:71], v[164:167]
    v_perm_b32 v33, v240, v60, s43
    v_perm_b32 v34, v240, v61, s42
    v_mfma_f32_16x16x32_bf16 v[160:163], v[84:87], v[68:71], v[160:163]
    v_perm_b32 v35, v240, v61, s43
    v_perm_b32 v36, v240, v62, s42
    v_mfma_f32_16x16x32_bf16 v[156:159], v[80:83], v[68:71], v[156:159]
    v_perm_b32 v37, v240, v62, s43
    v_perm_b32 v38, v240, v63, s42
    v_mfma_f32_16x16x32_bf16 v[184:187], v[80:83], v[72:75], v[184:187]
    v_perm_b32 v39, v240, v63, s43
    s_waitcnt lgkmcnt(5)
    v_mfma_f32_16x16x32_bf16 v[188:191], v[84:87], v[72:75], v[188:191]
    v_perm_b32 v40, v240, v108, s42
    v_perm_b32 v41, v240, v108, s43
    v_mfma_f32_16x16x32_bf16 v[192:195], v[88:91], v[72:75], v[192:195]
    v_perm_b32 v42, v240, v109, s42
    v_perm_b32 v43, v240, v109, s43
    v_mfma_f32_16x16x32_bf16 v[196:199], v[92:95], v[72:75], v[196:199]
    v_perm_b32 v44, v240, v110, s42
    v_perm_b32 v45, v240, v110, s43
    v_mfma_f32_16x16x32_bf16 v[200:203], v[96:99], v[72:75], v[200:203]
    v_perm_b32 v46, v240, v111, s42
    v_perm_b32 v47, v240, v111, s43
    v_mfma_f32_16x16x32_bf16 v[204:207], v[100:103], v[72:75], v[204:207]
    v_perm_b32 v48, v240, v112, s42
    v_perm_b32 v49, v240, v112, s43
    v_mfma_f32_16x16x32_bf16 v[208:211], v[104:107], v[72:75], v[208:211]
    v_perm_b32 v50, v240, v113, s42
    v_perm_b32 v51, v240, v113, s43
    v_mfma_f32_16x16x32_bf16 v[236:239], v[104:107], v[76:79], v[236:239]
    v_perm_b32 v52, v240, v114, s42
    v_perm_b32 v53, v240, v114, s43
    v_mfma_f32_16x16x32_bf16 v[232:235], v[100:103], v[76:79], v[232:235]
    v_perm_b32 v54, v240, v115, s42
    v_perm_b32 v55, v240, v115, s43
    v_mfma_f32_16x16x32_bf16 v[228:231], v[96:99], v[76:79], v[228:231]
    v_perm_b32 v56, v240, v116, s42
    v_perm_b32 v57, v240, v116, s43
    v_mfma_f32_16x16x32_bf16 v[224:227], v[92:95], v[76:79], v[224:227]
    v_perm_b32 v58, v240, v117, s42
    v_perm_b32 v59, v240, v117, s43
    s_waitcnt lgkmcnt(0)
    v_mfma_f32_16x16x32_bf16 v[220:223], v[88:91], v[76:79], v[220:223]
    ds_read_b32 v13, v12
    v_mfma_f32_16x16x32_bf16 v[216:219], v[84:87], v[76:79], v[216:219]
    ds_read_b128 v[124:127], v10 offset:7424
    v_mfma_f32_16x16x32_bf16 v[212:215], v[80:83], v[76:79], v[212:215]
    ds_read_b64 v[122:123], v11 offset:7168
    v_add_u32 v118, 92160, v118
    v_add_u32 v119, 92160, v119
    v_add_u32 v120, 92160, v120
    v_add_u32 v121, 92160, v121
    s_waitcnt lgkmcnt(2)
    v_cmp_gt_i32 vcc, 15, v13
    s_nop 1
    s_cbranch_vccnz L_fs_21
L_fb_22:
    v_mfma_f32_16x16x32_bf16 v[144:147], v[48:51], v[16:19], v[144:147]
    ds_read_b128 v[112:115], v10 offset:30976
    v_mfma_f32_16x16x32_bf16 v[148:151], v[52:55], v[16:19], v[148:151]
    ds_read_b64 v[116:117], v11 offset:30720
    v_mfma_f32_16x16x32_bf16 v[152:155], v[56:59], v[16:19], v[152:155]
    ds_read_b128 v[64:67], v9 offset:0
    v_mfma_f32_16x16x32_bf16 v[180:183], v[56:59], v[20:23], v[180:183]
    ds_read_b128 v[68:71], v9 offset:2048
    v_mfma_f32_16x16x32_bf16 v[176:179], v[52:55], v[20:23], v[176:179]
    ds_read_b128 v[72:75], v9 offset:4096
    v_mfma_f32_16x16x32_bf16 v[172:175], v[48:51], v[20:23], v[172:175]
    ds_read_b128 v[76:79], v9 offset:6144
    v_mfma_f32_16x16x32_bf16 v[200:203], v[48:51], v[24:27], v[200:203]
    s_waitcnt lgkmcnt(6)
    v_perm_b32 v96, v240, v124, s42
    v_perm_b32 v97, v240, v124, s43
    v_mfma_f32_16x16x32_bf16 v[204:207], v[52:55], v[24:27], v[204:207]
    v_perm_b32 v98, v240, v125, s42
    v_perm_b32 v99, v240, v125, s43
    v_mfma_f32_16x16x32_bf16 v[208:211], v[56:59], v[24:27], v[208:211]
    v_perm_b32 v100, v240, v126, s42
    v_perm_b32 v101, v240, v126, s43
    v_mfma_f32_16x16x32_bf16 v[236:239], v[56:59], v[28:31], v[236:239]
    v_perm_b32 v102, v240, v127, s42
    v_perm_b32 v103, v240, v127, s43
    v_mfma_f32_16x16x32_bf16 v[232:235], v[52:55], v[28:31], v[232:235]
    v_perm_b32 v104, v240, v122, s42
    v_perm_b32 v105, v240, v122, s43
    v_mfma_f32_16x16x32_bf16 v[228:231], v[48:51], v[28:31], v[228:231]
    v_perm_b32 v106, v240, v123, s42
    v_perm_b32 v107, v240, v123, s43
    s_waitcnt lgkmcnt(3)
    v_mfma_f32_16x16x32_bf16 v[144:147], v[96:99], v[64:67], v[144:147]
    ds_read_b128 v[124:127], v10 offset:38144
    v_mfma_f32_16x16x32_bf16 v[148:151], v[100:103], v[64:67], v[148:151]
    ds_read_b64 v[122:123], v11 offset:37888
    v_mfma_f32_16x16x32_bf16 v[152:155], v[104:107], v[64:67], v[152:155]
    ds_read_b128 v[16:19], v8 offset:30720
    s_waitcnt lgkmcnt(5)
    v_mfma_f32_16x16x32_bf16 v[180:183], v[104:107], v[68:71], v[180:183]
    ds_read_b128 v[20:23], v8 offset:32768
    v_mfma_f32_16x16x32_bf16 v[176:179], v[100:103], v[68:71], v[176:179]
    ds_read_b128 v[24:27], v8 offset:34816
    v_mfma_f32_16x16x32_bf16 v[172:175], v[96:99], v[68:71], v[172:175]
    ds_read_b128 v[28:31], v8 offset:36864
    ds_read_b32 v13, v12
    s_waitcnt lgkmcnt(8)
    v_mfma_f32_16x16x32_bf16 v[200:203], v[96:99], v[72:75], v[200:203]
    v_perm_b32 v48, v240, v112, s42
    v_perm_b32 v49, v240, v112, s43
    v_mfma_f32_16x16x32_bf16 v[204:207], v[100:103], v[72:75], v[204:207]
    v_perm_b32 v50, v240, v113, s42
    v_perm_b32 v51, v240, v113, s43
    v_mfma_f32_16x16x32_bf16 v[208:211], v[104:107], v[72:75], v[208:211]
    v_perm_b32 v52, v240, v114, s42
    v_perm_b32 v53, v240, v114, s43
    s_waitcnt lgkmcnt(7)
    v_mfma_f32_16x16x32_bf16 v[236:239], v[104:107], v[76:79], v[236:239]
    v_perm_b32 v54, v240, v115, s42
    v_perm_b32 v55, v240, v115, s43
    v_mfma_f32_16x16x32_bf16 v[232:235], v[100:103], v[76:79], v[232:235]
    v_perm_b32 v56, v240, v116, s42
    v_perm_b32 v57, v240, v116, s43
    v_mfma_f32_16x16x32_bf16 v[228:231], v[96:99], v[76:79], v[228:231]
    v_perm_b32 v58, v240, v117, s42
    v_perm_b32 v59, v240, v117, s43
    s_waitcnt lgkmcnt(0)
    v_cmp_gt_i32 vcc, 16, v13
    s_nop 1
    s_cbranch_vccnz L_fs_23
L_fb_24:
    v_mfma_f32_16x16x32_bf16 v[144:147], v[48:51], v[16:19], v[144:147]
    ds_read_b128 v[112:115], v120 offset:256
    v_mfma_f32_16x16x32_bf16 v[148:151], v[52:55], v[16:19], v[148:151]
    ds_read_b64 v[116:117], v121 offset:0
    v_mfma_f32_16x16x32_bf16 v[152:155], v[56:59], v[16:19], v[152:155]
    ds_read_b128 v[64:67], v9 offset:30720
    v_mfma_f32_16x16x32_bf16 v[180:183], v[56:59], v[20:23], v[180:183]
    ds_read_b128 v[68:71], v9 offset:32768
    v_mfma_f32_16x16x32_bf16 v[176:179], v[52:55], v[20:23], v[176:179]
    ds_read_b128 v[72:75], v9 offset:34816
    v_mfma_f32_16x16x32_bf16 v[172:175], v[48:51], v[20:23], v[172:175]
    ds_read_b128 v[76:79], v9 offset:36864
    v_mfma_f32_16x16x32_bf16 v[200:203], v[48:51], v[24:27], v[200:203]
    v_perm_b32 v96, v240, v124, s42
    v_perm_b32 v97, v240, v124, s43
    v_mfma_f32_16x16x32_bf16 v[204:207], v[52:55], v[24:27], v[204:207]
    v_perm_b32 v98, v240, v125, s42
    v_perm_b32 v99, v240, v125, s43
    v_mfma_f32_16x16x32_bf16 v[208:211], v[56:59], v[24:27], v[208:211]
    v_perm_b32 v100, v240, v126, s42
    v_perm_b32 v101, v240, v126, s43
    v_mfma_f32_16x16x32_bf16 v[236:239], v[56:59], v[28:31], v[236:239]
    v_perm_b32 v102, v240, v127, s42
    v_perm_b32 v103, v240, v127, s43
    v_mfma_f32_16x16x32_bf16 v[232:235], v[52:55], v[28:31], v[232:235]
    v_perm_b32 v104, v240, v122, s42
    v_perm_b32 v105, v240, v122, s43
    v_mfma_f32_16x16x32_bf16 v[228:231], v[48:51], v[28:31], v[228:231]
    v_perm_b32 v106, v240, v123, s42
    v_perm_b32 v107, v240, v123, s43
    s_waitcnt lgkmcnt(3)
    v_mfma_f32_16x16x32_bf16 v[144:147], v[96:99], v[64:67], v[144:147]
    ds_read_b128 v[124:127], v120 offset:7424
    v_mfma_f32_16x16x32_bf16 v[148:151], v[100:103], v[64:67], v[148:151]
    ds_read_b64 v[122:123], v121 offset:7168
    v_mfma_f32_16x16x32_bf16 v[152:155], v[104:107], v[64:67], v[152:155]
    ds_read_b128 v[16:19], v118 offset:0
    s_waitcnt lgkmcnt(5)
    v_mfma_f32_16x16x32_bf16 v[180:183], v[104:107], v[68:71], v[180:183]
    ds_read_b128 v[20:23], v118 offset:2048
    v_mfma_f32_16x16x32_bf16 v[176:179], v[100:103], v[68:71], v[176:179]
    ds_read_b128 v[24:27], v118 offset:4096
    v_mfma_f32_16x16x32_bf16 v[172:175], v[96:99], v[68:71], v[172:175]
    ds_read_b128 v[28:31], v118 offset:6144
    s_waitcnt lgkmcnt(7)
    v_mfma_f32_16x16x32_bf16 v[200:203], v[96:99], v[72:75], v[200:203]
    v_perm_b32 v48, v240, v112, s42
    v_perm_b32 v49, v240, v112, s43
    v_mfma_f32_16x16x32_bf16 v[204:207], v[100:103], v[72:75], v[204:207]
    v_perm_b32 v50, v240, v113, s42
    v_perm_b32 v51, v240, v113, s43
    v_mfma_f32_16x16x32_bf16 v[208:211], v[104:107], v[72:75], v[208:211]
    v_perm_b32 v52, v240, v114, s42
    v_perm_b32 v53, v240, v114, s43
    s_waitcnt lgkmcnt(6)
    v_mfma_f32_16x16x32_bf16 v[236:239], v[104:107], v[76:79], v[236:239]
    v_perm_b32 v54, v240, v115, s42
    v_perm_b32 v55, v240, v115, s43
    v_mfma_f32_16x16x32_bf16 v[232:235], v[100:103], v[76:79], v[232:235]
    v_perm_b32 v56, v240, v116, s42
    v_perm_b32 v57, v240, v116, s43
    v_mfma_f32_16x16x32_bf16 v[228:231], v[96:99], v[76:79], v[228:231]
    v_perm_b32 v58, v240, v117, s42
    v_perm_b32 v59, v240, v117, s43
    s_waitcnt lgkmcnt(3)
    v_mfma_f32_16x16x32_bf16 v[144:147], v[48:51], v[16:19], v[144:147]
    ds_read_b32 v13, v5
    v_mfma_f32_16x16x32_bf16 v[148:151], v[52:55], v[16:19], v[148:151]
    ds_read_b128 v[64:67], v119 offset:0
    v_mfma_f32_16x16x32_bf16 v[152:155], v[56:59], v[16:19], v[152:155]
    ds_read_b128 v[68:71], v119 offset:2048
    s_waitcnt lgkmcnt(5)
    v_mfma_f32_16x16x32_bf16 v[180:183], v[56:59], v[20:23], v[180:183]
    ds_read_b128 v[72:75], v119 offset:4096
    v_mfma_f32_16x16x32_bf16 v[176:179], v[52:55], v[20:23], v[176:179]
    ds_read_b128 v[76:79], v119 offset:6144
    v_mfma_f32_16x16x32_bf16 v[172:175], v[48:51], v[20:23], v[172:175]
    v_perm_b32 v96, v240, v124, s42
    v_perm_b32 v97, v240, v124, s43
    s_waitcnt lgkmcnt(6)
    v_mfma_f32_16x16x32_bf16 v[200:203], v[48:51], v[24:27], v[200:203]
    v_perm_b32 v98, v240, v125, s42
    v_perm_b32 v99, v240, v125, s43
    v_mfma_f32_16x16x32_bf16 v[204:207], v[52:55], v[24:27], v[204:207]
    v_perm_b32 v100, v240, v126, s42
    v_perm_b32 v101, v240, v126, s43
    v_mfma_f32_16x16x32_bf16 v[208:211], v[56:59], v[24:27], v[208:211]
    v_perm_b32 v102, v240, v127, s42
    v_perm_b32 v103, v240, v127, s43
    s_waitcnt lgkmcnt(5)
    v_mfma_f32_16x16x32_bf16 v[236:239], v[56:59], v[28:31], v[236:239]
    v_perm_b32 v104, v240, v122, s42
    v_perm_b32 v105, v240, v122, s43
    v_mfma_f32_16x16x32_bf16 v[232:235], v[52:55], v[28:31], v[232:235]
    v_perm_b32 v106, v240, v123, s42
    v_perm_b32 v107, v240, v123, s43
    v_mfma_f32_16x16x32_bf16 v[228:231], v[48:51], v[28:31], v[228:231]
    s_waitcnt lgkmcnt(4)
    v_cmp_gt_i32 vcc, 13, v13
    s_nop 1
    s_cbranch_vccnz L_fs_25
L_fb_26:
    s_waitcnt lgkmcnt(3)
    v_mfma_f32_16x16x32_bf16 v[144:147], v[96:99], v[64:67], v[144:147]
    ds_read_b128 v[92:95], v241 offset:1152
    ds_read_b128 v[244:247], v242
    v_mfma_f32_16x16x32_bf16 v[148:151], v[100:103], v[64:67], v[148:151]
    ds_read_b128 v[248:251], v241 offset:1216
    v_mfma_f32_16x16x32_bf16 v[152:155], v[104:107], v[64:67], v[152:155]
    ds_read_b128 v[252:255], v241 offset:1280
    s_waitcnt lgkmcnt(6)
    v_mfma_f32_16x16x32_bf16 v[180:183], v[104:107], v[68:71], v[180:183]
    ds_read_b128 v[80:83], v241 offset:256
    v_mfma_f32_16x16x32_bf16 v[176:179], v[100:103], v[68:71], v[176:179]
    ds_read_b128 v[84:87], v241 offset:320
    v_mfma_f32_16x16x32_bf16 v[172:175], v[96:99], v[68:71], v[172:175]
    ds_read_b128 v[88:91], v241 offset:384
    s_waitcnt lgkmcnt(8)
    v_mfma_f32_16x16x32_bf16 v[200:203], v[96:99], v[72:75], v[200:203]
    ds_read_b128 v[60:63], v10 offset:7168
    v_mfma_f32_16x16x32_bf16 v[204:207], v[100:103], v[72:75], v[204:207]
    ds_read_b128 v[108:111], v10 offset:7296
    v_mfma_f32_16x16x32_bf16 v[208:211], v[104:107], v[72:75], v[208:211]
    ds_read_b128 v[16:19], v8 offset:0
    s_waitcnt lgkmcnt(10)
    v_mfma_f32_16x16x32_bf16 v[236:239], v[104:107], v[76:79], v[236:239]
    ds_read_b128 v[20:23], v8 offset:2048
    v_mfma_f32_16x16x32_bf16 v[232:235], v[100:103], v[76:79], v[232:235]
    ds_read_b128 v[24:27], v8 offset:4096
    v_mfma_f32_16x16x32_bf16 v[228:231], v[96:99], v[76:79], v[228:231]
    ds_read_b128 v[28:31], v8 offset:6144
    s_waitcnt lgkmcnt(6)
    v_pk_fma_f32 v[144:145], v[92:93], v[244:245], v[144:145] op_sel:[0,0,0] op_sel_hi:[1,0,1]
    v_pk_fma_f32 v[146:147], v[94:95], v[244:245], v[146:147] op_sel:[0,0,0] op_sel_hi:[1,0,1]
    v_pk_fma_f32 v[148:149], v[248:249], v[244:245], v[148:149] op_sel:[0,0,0] op_sel_hi:[1,0,1]
    v_pk_fma_f32 v[150:151], v[250:251], v[244:245], v[150:151] op_sel:[0,0,0] op_sel_hi:[1,0,1]
    v_pk_fma_f32 v[152:153], v[252:253], v[244:245], v[152:153] op_sel:[0,0,0] op_sel_hi:[1,0,1]
    v_pk_fma_f32 v[154:155], v[254:255], v[244:245], v[154:155] op_sel:[0,0,0] op_sel_hi:[1,0,1]
    v_pk_mul_f32 v[144:145], v[144:145], v[80:81]
    v_pk_mul_f32 v[146:147], v[146:147], v[82:83]
    v_pk_mul_f32 v[148:149], v[148:149], v[84:85]
    v_pk_mul_f32 v[150:151], v[150:151], v[86:87]
    v_pk_mul_f32 v[152:153], v[152:153], v[88:89]
    v_pk_mul_f32 v[154:155], v[154:155], v[90:91]
    v_cvt_pk_bf16_f32 v48, v144, v148
    v_cvt_pk_bf16_f32 v49, v145, v149
    v_cvt_pk_bf16_f32 v50, v146, v150
    v_cvt_pk_bf16_f32 v51, v147, v151
    v_cvt_pk_bf16_f32 v52, v152, v153
    v_cvt_pk_bf16_f32 v53, v154, v155
    s_waitcnt lgkmcnt(0)
    ds_write_b128 v6, v[48:51] offset:0
    ds_write_b64 v7, v[52:53] offset:128
    v_pk_fma_f32 v[172:173], v[92:93], v[244:245], v[172:173] op_sel:[0,1,0] op_sel_hi:[1,1,1]
    v_pk_fma_f32 v[174:175], v[94:95], v[244:245], v[174:175] op_sel:[0,1,0] op_sel_hi:[1,1,1]
    v_pk_fma_f32 v[176:177], v[248:249], v[244:245], v[176:177] op_sel:[0,1,0] op_sel_hi:[1,1,1]
    v_pk_fma_f32 v[178:179], v[250:251], v[244:245], v[178:179] op_sel:[0,1,0] op_sel_hi:[1,1,1]
    v_pk_fma_f32 v[180:181], v[252:253], v[244:245], v[180:181] op_sel:[0,1,0] op_sel_hi:[1,1,1]
    v_pk_fma_f32 v[182:183], v[254:255], v[244:245], v[182:183] op_sel:[0,1,0] op_sel_hi:[1,1,1]
    v_pk_mul_f32 v[172:173], v[172:173], v[80:81]
    v_pk_mul_f32 v[174:175], v[174:175], v[82:83]
    v_pk_mul_f32 v[176:177], v[176:177], v[84:85]
    v_pk_mul_f32 v[178:179], v[178:179], v[86:87]
    v_pk_mul_f32 v[180:181], v[180:181], v[88:89]
    v_pk_mul_f32 v[182:183], v[182:183], v[90:91]
    v_cvt_pk_bf16_f32 v96, v172, v176
    v_cvt_pk_bf16_f32 v97, v173, v177
    v_cvt_pk_bf16_f32 v98, v174, v178
    v_cvt_pk_bf16_f32 v99, v175, v179
    v_cvt_pk_bf16_f32 v100, v180, v181
    v_cvt_pk_bf16_f32 v101, v182, v183
    ds_write_b128 v6, v[96:99] offset:3072
    ds_write_b64 v7, v[100:101] offset:3200
    v_pk_fma_f32 v[200:201], v[92:93], v[246:247], v[200:201] op_sel:[0,0,0] op_sel_hi:[1,0,1]
    v_pk_fma_f32 v[202:203], v[94:95], v[246:247], v[202:203] op_sel:[0,0,0] op_sel_hi:[1,0,1]
    v_pk_fma_f32 v[204:205], v[248:249], v[246:247], v[204:205] op_sel:[0,0,0] op_sel_hi:[1,0,1]
    v_pk_fma_f32 v[206:207], v[250:251], v[246:247], v[206:207] op_sel:[0,0,0] op_sel_hi:[1,0,1]
    v_pk_fma_f32 v[208:209], v[252:253], v[246:247], v[208:209] op_sel:[0,0,0] op_sel_hi:[1,0,1]
    v_pk_fma_f32 v[210:211], v[254:255], v[246:247], v[210:211] op_sel:[0,0,0] op_sel_hi:[1,0,1]
    v_pk_mul_f32 v[200:201], v[200:201], v[80:81]
    v_pk_mul_f32 v[202:203], v[202:203], v[82:83]
    v_pk_mul_f32 v[204:205], v[204:205], v[84:85]
    v_pk_mul_f32 v[206:207], v[206:207], v[86:87]
    v_pk_mul_f32 v[208:209], v[208:209], v[88:89]
    v_pk_mul_f32 v[210:211], v[210:211], v[90:91]
    v_cvt_pk_bf16_f32 v54, v200, v204
    v_cvt_pk_bf16_f32 v55, v201, v205
    v_cvt_pk_bf16_f32 v56, v202, v206
    v_cvt_pk_bf16_f32 v57, v203, v207
    v_cvt_pk_bf16_f32 v58, v208, v209
    v_cvt_pk_bf16_f32 v59, v210, v211
    ds_write_b128 v6, v[54:57] offset:6144
    ds_write_b64 v7, v[58:59] offset:6272
    v_pk_fma_f32 v[228:229], v[92:93], v[246:247], v[228:229] op_sel:[0,1,0] op_sel_hi:[1,1,1]
    v_pk_fma_f32 v[230:231], v[94:95], v[246:247], v[230:231] op_sel:[0,1,0] op_sel_hi:[1,1,1]
    v_pk_fma_f32 v[232:233], v[248:249], v[246:247], v[232:233] op_sel:[0,1,0] op_sel_hi:[1,1,1]
    v_pk_fma_f32 v[234:235], v[250:251], v[246:247], v[234:235] op_sel:[0,1,0] op_sel_hi:[1,1,1]
    v_pk_fma_f32 v[236:237], v[252:253], v[246:247], v[236:237] op_sel:[0,1,0] op_sel_hi:[1,1,1]
    v_pk_fma_f32 v[238:239], v[254:255], v[246:247], v[238:239] op_sel:[0,1,0] op_sel_hi:[1,1,1]
    v_pk_mul_f32 v[228:229], v[228:229], v[80:81]
    v_pk_mul_f32 v[230:231], v[230:231], v[82:83]
    v_pk_mul_f32 v[232:233], v[232:233], v[84:85]
    v_pk_mul_f32 v[234:235], v[234:235], v[86:87]
    v_pk_mul_f32 v[236:237], v[236:237], v[88:89]
    v_pk_mul_f32 v[238:239], v[238:239], v[90:91]
    v_cvt_pk_bf16_f32 v102, v228, v232
    v_cvt_pk_bf16_f32 v103, v229, v233
    v_cvt_pk_bf16_f32 v104, v230, v234
    v_cvt_pk_bf16_f32 v105, v231, v235
    v_cvt_pk_bf16_f32 v106, v236, v237
    v_cvt_pk_bf16_f32 v107, v238, v239
    ds_write_b128 v6, v[102:105] offset:9216
    ds_write_b64 v7, v[106:107] offset:9344
    ds_write_b32 v14, v15 offset:32
    v_mfma_f32_16x16x32_bf16 v[128:131], v[32:35], v[16:19], v[128:131]
    ds_read_b128 v[112:115], v10 offset:30720
    v_mfma_f32_16x16x32_bf16 v[132:135], v[36:39], v[16:19], v[132:135]
    ds_read_b128 v[124:127], v10 offset:30848
    v_mfma_f32_16x16x32_bf16 v[136:139], v[40:43], v[16:19], v[136:139]
    ds_read_b128 v[64:67], v9 offset:0
    v_mfma_f32_16x16x32_bf16 v[140:143], v[44:47], v[16:19], v[140:143]
    ds_read_b128 v[68:71], v9 offset:2048
    v_mfma_f32_16x16x32_bf16 v[168:171], v[44:47], v[20:23], v[168:171]
    ds_read_b128 v[72:75], v9 offset:4096
    v_mfma_f32_16x16x32_bf16 v[164:167], v[40:43], v[20:23], v[164:167]
    ds_read_b128 v[76:79], v9 offset:6144
    v_mfma_f32_16x16x32_bf16 v[160:163], v[36:39], v[20:23], v[160:163]
    ds_read_b128 v[144:147], v241 offset:0
    v_mfma_f32_16x16x32_bf16 v[156:159], v[32:35], v[20:23], v[156:159]
    ds_read_b128 v[176:179], v241 offset:896
    v_mfma_f32_16x16x32_bf16 v[184:187], v[32:35], v[24:27], v[184:187]
    v_perm_b32 v80, v240, v60, s42
    v_perm_b32 v81, v240, v60, s43
    v_mfma_f32_16x16x32_bf16 v[188:191], v[36:39], v[24:27], v[188:191]
    v_perm_b32 v82, v240, v61, s42
    v_perm_b32 v83, v240, v61, s43
    v_mfma_f32_16x16x32_bf16 v[192:195], v[40:43], v[24:27], v[192:195]
    v_perm_b32 v84, v240, v62, s42
    v_perm_b32 v85, v240, v62, s43
    v_mfma_f32_16x16x32_bf16 v[196:199], v[44:47], v[24:27], v[196:199]
    v_perm_b32 v86, v240, v63, s42
    v_perm_b32 v87, v240, v63, s43
    v_mfma_f32_16x16x32_bf16 v[224:227], v[44:47], v[28:31], v[224:227]
    v_perm_b32 v88, v240, v108, s42
    v_perm_b32 v89, v240, v108, s43
    v_mfma_f32_16x16x32_bf16 v[220:223], v[40:43], v[28:31], v[220:223]
    v_perm_b32 v90, v240, v109, s42
    v_perm_b32 v91, v240, v109, s43
    v_mfma_f32_16x16x32_bf16 v[216:219], v[36:39], v[28:31], v[216:219]
    v_perm_b32 v92, v240, v110, s42
    v_perm_b32 v93, v240, v110, s43
    v_mfma_f32_16x16x32_bf16 v[212:215], v[32:35], v[28:31], v[212:215]
    v_perm_b32 v94, v240, v111, s42
    v_perm_b32 v95, v240, v111, s43
    s_waitcnt lgkmcnt(5)
    v_mfma_f32_16x16x32_bf16 v[128:131], v[80:83], v[64:67], v[128:131]
    ds_read_b128 v[60:63], v10 offset:37888
    v_mfma_f32_16x16x32_bf16 v[132:135], v[84:87], v[64:67], v[132:135]
    ds_read_b128 v[108:111], v10 offset:38016
    v_mfma_f32_16x16x32_bf16 v[136:139], v[88:91], v[64:67], v[136:139]
    ds_read_b128 v[16:19], v8 offset:30720
    v_mfma_f32_16x16x32_bf16 v[140:143], v[92:95], v[64:67], v[140:143]
    ds_read_b128 v[20:23], v8 offset:32768
    s_waitcnt lgkmcnt(8)
    v_mfma_f32_16x16x32_bf16 v[168:171], v[92:95], v[68:71], v[168:171]
    ds_read_b128 v[24:27], v8 offset:34816
    v_mfma_f32_16x16x32_bf16 v[164:167], v[88:91], v[68:71], v[164:167]
    ds_read_b128 v[28:31], v8 offset:36864
    v_mfma_f32_16x16x32_bf16 v[160:163], v[84:87], v[68:71], v[160:163]
    ds_read_b128 v[148:151], v241 offset:64
    v_mfma_f32_16x16x32_bf16 v[156:159], v[80:83], v[68:71], v[156:159]
    ds_read_b128 v[180:183], v241 offset:960
    s_waitcnt lgkmcnt(11)
    v_mfma_f32_16x16x32_bf16 v[184:187], v[80:83], v[72:75], v[184:187]
    v_perm_b32 v32, v240, v112, s42
    v_perm_b32 v33, v240, v112, s43
    v_mfma_f32_16x16x32_bf16 v[188:191], v[84:87], v[72:75], v[188:191]
    v_perm_b32 v34, v240, v113, s42
    v_perm_b32 v35, v240, v113, s43
    v_mfma_f32_16x16x32_bf16 v[192:195], v[88:91], v[72:75], v[192:195]
    v_perm_b32 v36, v240, v114, s42
    v_perm_b32 v37, v240, v114, s43
    v_mfma_f32_16x16x32_bf16 v[196:199], v[92:95], v[72:75], v[196:199]
    v_perm_b32 v38, v240, v115, s42
    v_perm_b32 v39, v240, v115, s43
    s_waitcnt lgkmcnt(10)
    v_mfma_f32_16x16x32_bf16 v[224:227], v[92:95], v[76:79], v[224:227]
    v_perm_b32 v40, v240, v124, s42
    v_perm_b32 v41, v240, v124, s43
    v_mfma_f32_16x16x32_bf16 v[220:223], v[88:91], v[76:79], v[220:223]
    v_perm_b32 v42, v240, v125, s42
    v_perm_b32 v43, v240, v125, s43
    v_mfma_f32_16x16x32_bf16 v[216:219], v[84:87], v[76:79], v[216:219]
    v_perm_b32 v44, v240, v126, s42
    v_perm_b32 v45, v240, v126, s43
    v_mfma_f32_16x16x32_bf16 v[212:215], v[80:83], v[76:79], v[212:215]
    v_perm_b32 v46, v240, v127, s42
    v_perm_b32 v47, v240, v127, s43
    s_waitcnt lgkmcnt(5)
    v_mfma_f32_16x16x32_bf16 v[128:131], v[32:35], v[16:19], v[128:131]
    ds_read_b128 v[112:115], v120 offset:0
    v_mfma_f32_16x16x32_bf16 v[132:135], v[36:39], v[16:19], v[132:135]
    ds_read_b128 v[124:127], v120 offset:128
    v_mfma_f32_16x16x32_bf16 v[136:139], v[40:43], v[16:19], v[136:139]
    ds_read_b128 v[64:67], v9 offset:30720
    v_mfma_f32_16x16x32_bf16 v[140:143], v[44:47], v[16:19], v[140:143]
    ds_read_b128 v[68:71], v9 offset:32768
    s_waitcnt lgkmcnt(8)
    v_mfma_f32_16x16x32_bf16 v[168:171], v[44:47], v[20:23], v[168:171]
    ds_read_b128 v[72:75], v9 offset:34816
    v_mfma_f32_16x16x32_bf16 v[164:167], v[40:43], v[20:23], v[164:167]
    ds_read_b128 v[76:79], v9 offset:36864
    v_mfma_f32_16x16x32_bf16 v[160:163], v[36:39], v[20:23], v[160:163]
    ds_read_b128 v[152:155], v241 offset:128
    v_mfma_f32_16x16x32_bf16 v[156:159], v[32:35], v[20:23], v[156:159]
    ds_read_b128 v[200:203], v241 offset:1024
    s_waitcnt lgkmcnt(11)
    v_mfma_f32_16x16x32_bf16 v[184:187], v[32:35], v[24:27], v[184:187]
    v_perm_b32 v80, v240, v60, s42
    v_perm_b32 v81, v240, v60, s43
    v_mfma_f32_16x16x32_bf16 v[188:191], v[36:39], v[24:27], v[188:191]
    v_perm_b32 v82, v240, v61, s42
    v_perm_b32 v83, v240, v61, s43
    v_mfma_f32_16x16x32_bf16 v[192:195], v[40:43], v[24:27], v[192:195]
    v_perm_b32 v84, v240, v62, s42
    v_perm_b32 v85, v240, v62, s43
    v_mfma_f32_16x16x32_bf16 v[196:199], v[44:47], v[24:27], v[196:199]
    v_perm_b32 v86, v240, v63, s42
    v_perm_b32 v87, v240, v63, s43
    s_waitcnt lgkmcnt(10)
    v_mfma_f32_16x16x32_bf16 v[224:227], v[44:47], v[28:31], v[224:227]
    v_perm_b32 v88, v240, v108, s42
    v_perm_b32 v89, v240, v108, s43
    v_mfma_f32_16x16x32_bf16 v[220:223], v[40:43], v[28:31], v[220:223]
    v_perm_b32 v90, v240, v109, s42
    v_perm_b32 v91, v240, v109, s43
    v_mfma_f32_16x16x32_bf16 v[216:219], v[36:39], v[28:31], v[216:219]
    v_perm_b32 v92, v240, v110, s42
    v_perm_b32 v93, v240, v110, s43
    v_mfma_f32_16x16x32_bf16 v[212:215], v[32:35], v[28:31], v[212:215]
    v_perm_b32 v94, v240, v111, s42
    v_perm_b32 v95, v240, v111, s43
    s_waitcnt lgkmcnt(5)
    v_mfma_f32_16x16x32_bf16 v[128:131], v[80:83], v[64:67], v[128:131]
    ds_read_b128 v[60:63], v120 offset:7168
    v_mfma_f32_16x16x32_bf16 v[132:135], v[84:87], v[64:67], v[132:135]
    ds_read_b128 v[108:111], v120 offset:7296
    v_mfma_f32_16x16x32_bf16 v[136:139], v[88:91], v[64:67], v[136:139]
    ds_read_b128 v[16:19], v118 offset:0
    v_mfma_f32_16x16x32_bf16 v[140:143], v[92:95], v[64:67], v[140:143]
    ds_read_b128 v[20:23], v118 offset:2048
    s_waitcnt lgkmcnt(8)
    v_mfma_f32_16x16x32_bf16 v[168:171], v[92:95], v[68:71], v[168:171]
    ds_read_b128 v[24:27], v118 offset:4096
    v_mfma_f32_16x16x32_bf16 v[164:167], v[88:91], v[68:71], v[164:167]
    ds_read_b128 v[28:31], v118 offset:6144
    v_mfma_f32_16x16x32_bf16 v[160:163], v[84:87], v[68:71], v[160:163]
    ds_read_b128 v[172:175], v241 offset:192
    v_mfma_f32_16x16x32_bf16 v[156:159], v[80:83], v[68:71], v[156:159]
    ds_read_b128 v[204:207], v241 offset:1088
    s_waitcnt lgkmcnt(11)
    v_mfma_f32_16x16x32_bf16 v[184:187], v[80:83], v[72:75], v[184:187]
    v_perm_b32 v32, v240, v112, s42
    v_perm_b32 v33, v240, v112, s43
    v_mfma_f32_16x16x32_bf16 v[188:191], v[84:87], v[72:75], v[188:191]
    v_perm_b32 v34, v240, v113, s42
    v_perm_b32 v35, v240, v113, s43
    v_mfma_f32_16x16x32_bf16 v[192:195], v[88:91], v[72:75], v[192:195]
    v_perm_b32 v36, v240, v114, s42
    v_perm_b32 v37, v240, v114, s43
    v_mfma_f32_16x16x32_bf16 v[196:199], v[92:95], v[72:75], v[196:199]
    v_perm_b32 v38, v240, v115, s42
    v_perm_b32 v39, v240, v115, s43
    s_waitcnt lgkmcnt(10)
    v_mfma_f32_16x16x32_bf16 v[224:227], v[92:95], v[76:79], v[224:227]
    v_perm_b32 v40, v240, v124, s42
    v_perm_b32 v41, v240, v124, s43
    v_mfma_f32_16x16x32_bf16 v[220:223], v[88:91], v[76:79], v[220:223]
    v_perm_b32 v42, v240, v125, s42
    v_perm_b32 v43, v240, v125, s43
    v_mfma_f32_16x16x32_bf16 v[216:219], v[84:87], v[76:79], v[216:219]
    v_perm_b32 v44, v240, v126, s42
    v_perm_b32 v45, v240, v126, s43
    v_mfma_f32_16x16x32_bf16 v[212:215], v[80:83], v[76:79], v[212:215]
    v_perm_b32 v46, v240, v127, s42
    v_perm_b32 v47, v240, v127, s43
    s_waitcnt lgkmcnt(5)
    v_mfma_f32_16x16x32_bf16 v[128:131], v[32:35], v[16:19], v[128:131]
    ds_read_b128 v[64:67], v119 offset:0
    v_mfma_f32_16x16x32_bf16 v[132:135], v[36:39], v[16:19], v[132:135]
    ds_read_b128 v[68:71], v119 offset:2048
    v_mfma_f32_16x16x32_bf16 v[136:139], v[40:43], v[16:19], v[136:139]
    ds_read_b128 v[72:75], v119 offset:4096
    v_mfma_f32_16x16x32_bf16 v[140:143], v[44:47], v[16:19], v[140:143]
    ds_read_b128 v[76:79], v119 offset:6144
    s_waitcnt lgkmcnt(8)
    v_mfma_f32_16x16x32_bf16 v[168:171], v[44:47], v[20:23], v[168:171]
    v_perm_b32 v80, v240, v60, s42
    v_perm_b32 v81, v240, v60, s43
    v_mfma_f32_16x16x32_bf16 v[164:167], v[40:43], v[20:23], v[164:167]
    v_perm_b32 v82, v240, v61, s42
    v_perm_b32 v83, v240, v61, s43
    v_mfma_f32_16x16x32_bf16 v[160:163], v[36:39], v[20:23], v[160:163]
    v_perm_b32 v84, v240, v62, s42
    v_perm_b32 v85, v240, v62, s43
    v_mfma_f32_16x16x32_bf16 v[156:159], v[32:35], v[20:23], v[156:159]
    v_perm_b32 v86, v240, v63, s42
    v_perm_b32 v87, v240, v63, s43
    s_waitcnt lgkmcnt(7)
    v_mfma_f32_16x16x32_bf16 v[184:187], v[32:35], v[24:27], v[184:187]
    v_perm_b32 v88, v240, v108, s42
    v_perm_b32 v89, v240, v108, s43
    v_mfma_f32_16x16x32_bf16 v[188:191], v[36:39], v[24:27], v[188:191]
    v_perm_b32 v90, v240, v109, s42
    v_perm_b32 v91, v240, v109, s43
    v_mfma_f32_16x16x32_bf16 v[192:195], v[40:43], v[24:27], v[192:195]
    v_perm_b32 v92, v240, v110, s42
    v_perm_b32 v93, v240, v110, s43
    v_mfma_f32_16x16x32_bf16 v[196:199], v[44:47], v[24:27], v[196:199]
    v_perm_b32 v94, v240, v111, s42
    v_perm_b32 v95, v240, v111, s43
    s_waitcnt lgkmcnt(6)
    v_mfma_f32_16x16x32_bf16 v[224:227], v[44:47], v[28:31], v[224:227]
    v_mfma_f32_16x16x32_bf16 v[220:223], v[40:43], v[28:31], v[220:223]
    v_mfma_f32_16x16x32_bf16 v[216:219], v[36:39], v[28:31], v[216:219]
    v_mfma_f32_16x16x32_bf16 v[212:215], v[32:35], v[28:31], v[212:215]
    s_waitcnt lgkmcnt(3)
    v_mfma_f32_16x16x32_bf16 v[128:131], v[80:83], v[64:67], v[128:131]
    v_mfma_f32_16x16x32_bf16 v[132:135], v[84:87], v[64:67], v[132:135]
    v_mfma_f32_16x16x32_bf16 v[136:139], v[88:91], v[64:67], v[136:139]
    v_mfma_f32_16x16x32_bf16 v[140:143], v[92:95], v[64:67], v[140:143]
    s_waitcnt lgkmcnt(2)
    v_mfma_f32_16x16x32_bf16 v[168:171], v[92:95], v[68:71], v[168:171]
    v_mfma_f32_16x16x32_bf16 v[164:167], v[88:91], v[68:71], v[164:167]
    v_mfma_f32_16x16x32_bf16 v[160:163], v[84:87], v[68:71], v[160:163]
    v_mfma_f32_16x16x32_bf16 v[156:159], v[80:83], v[68:71], v[156:159]
    s_waitcnt lgkmcnt(1)
    v_mfma_f32_16x16x32_bf16 v[184:187], v[80:83], v[72:75], v[184:187]
    v_mfma_f32_16x16x32_bf16 v[188:191], v[84:87], v[72:75], v[188:191]
    v_mfma_f32_16x16x32_bf16 v[192:195], v[88:91], v[72:75], v[192:195]
    v_mfma_f32_16x16x32_bf16 v[196:199], v[92:95], v[72:75], v[196:199]
    s_waitcnt lgkmcnt(0)
    v_mfma_f32_16x16x32_bf16 v[224:227], v[92:95], v[76:79], v[224:227]
    v_mfma_f32_16x16x32_bf16 v[220:223], v[88:91], v[76:79], v[220:223]
    v_mfma_f32_16x16x32_bf16 v[216:219], v[84:87], v[76:79], v[216:219]
    v_mfma_f32_16x16x32_bf16 v[212:215], v[80:83], v[76:79], v[212:215]
L_epi:
    v_pk_fma_f32 v[128:129], v[176:177], v[244:245], v[128:129] op_sel:[0,0,0] op_sel_hi:[1,0,1]
    v_pk_fma_f32 v[130:131], v[178:179], v[244:245], v[130:131] op_sel:[0,0,0] op_sel_hi:[1,0,1]
    v_pk_fma_f32 v[132:133], v[180:181], v[244:245], v[132:133] op_sel:[0,0,0] op_sel_hi:[1,0,1]
    v_pk_fma_f32 v[134:135], v[182:183], v[244:245], v[134:135] op_sel:[0,0,0] op_sel_hi:[1,0,1]
    v_pk_fma_f32 v[136:137], v[200:201], v[244:245], v[136:137] op_sel:[0,0,0] op_sel_hi:[1,0,1]
    v_pk_fma_f32 v[138:139], v[202:203], v[244:245], v[138:139] op_sel:[0,0,0] op_sel_hi:[1,0,1]
    v_pk_fma_f32 v[140:141], v[204:205], v[244:245], v[140:141] op_sel:[0,0,0] op_sel_hi:[1,0,1]
    v_pk_fma_f32 v[142:143], v[206:207], v[244:245], v[142:143] op_sel:[0,0,0] op_sel_hi:[1,0,1]
    v_pk_mul_f32 v[128:129], v[128:129], v[144:145]
    v_pk_mul_f32 v[130:131], v[130:131], v[146:147]
    v_pk_mul_f32 v[132:133], v[132:133], v[148:149]
    v_pk_mul_f32 v[134:135], v[134:135], v[150:151]
    v_pk_mul_f32 v[136:137], v[136:137], v[152:153]
    v_pk_mul_f32 v[138:139], v[138:139], v[154:155]
    v_pk_mul_f32 v[140:141], v[140:141], v[172:173]
    v_pk_mul_f32 v[142:143], v[142:143], v[174:175]
    v_cvt_pk_bf16_f32 v16, v128, v132
    v_cvt_pk_bf16_f32 v17, v129, v133
    v_cvt_pk_bf16_f32 v18, v130, v134
    v_cvt_pk_bf16_f32 v19, v131, v135
    ds_write_b128 v0, v[16:19] offset:0
    v_cvt_pk_bf16_f32 v20, v136, v140
    v_cvt_pk_bf16_f32 v21, v137, v141
    v_cvt_pk_bf16_f32 v22, v138, v142
    v_cvt_pk_bf16_f32 v23, v139, v143
    ds_write_b128 v1, v[20:23] offset:0
    ds_read_b128 v[64:67], v3 offset:0
    ds_read_b128 v[68:71], v3 offset:1024
    v_pk_fma_f32 v[156:157], v[176:177], v[244:245], v[156:157] op_sel:[0,1,0] op_sel_hi:[1,1,1]
    v_pk_fma_f32 v[158:159], v[178:179], v[244:245], v[158:159] op_sel:[0,1,0] op_sel_hi:[1,1,1]
    v_pk_fma_f32 v[160:161], v[180:181], v[244:245], v[160:161] op_sel:[0,1,0] op_sel_hi:[1,1,1]
    v_pk_fma_f32 v[162:163], v[182:183], v[244:245], v[162:163] op_sel:[0,1,0] op_sel_hi:[1,1,1]
    v_pk_fma_f32 v[164:165], v[200:201], v[244:245], v[164:165] op_sel:[0,1,0] op_sel_hi:[1,1,1]
    v_pk_fma_f32 v[166:167], v[202:203], v[244:245], v[166:167] op_sel:[0,1,0] op_sel_hi:[1,1,1]
    v_pk_fma_f32 v[168:169], v[204:205], v[244:245], v[168:169] op_sel:[0,1,0] op_sel_hi:[1,1,1]
    v_pk_fma_f32 v[170:171], v[206:207], v[244:245], v[170:171] op_sel:[0,1,0] op_sel_hi:[1,1,1]
    v_pk_mul_f32 v[156:157], v[156:157], v[144:145]
    v_pk_mul_f32 v[158:159], v[158:159], v[146:147]
    v_pk_mul_f32 v[160:161], v[160:161], v[148:149]
    v_pk_mul_f32 v[162:163], v[162:163], v[150:151]
    v_pk_mul_f32 v[164:165], v[164:165], v[152:153]
    v_pk_mul_f32 v[166:167], v[166:167], v[154:155]
    v_pk_mul_f32 v[168:169], v[168:169], v[172:173]
    v_pk_mul_f32 v[170:171], v[170:171], v[174:175]
    v_cvt_pk_bf16_f32 v24, v156, v160
    v_cvt_pk_bf16_f32 v25, v157, v161
    v_cvt_pk_bf16_f32 v26, v158, v162
    v_cvt_pk_bf16_f32 v27, v159, v163
    ds_write_b128 v0, v[24:27] offset:2048
    v_cvt_pk_bf16_f32 v28, v164, v168
    v_cvt_pk_bf16_f32 v29, v165, v169
    v_cvt_pk_bf16_f32 v30, v166, v170
    v_cvt_pk_bf16_f32 v31, v167, v171
    ds_write_b128 v1, v[28:31] offset:2048
    ds_read_b128 v[72:75], v3 offset:2048
    ds_read_b128 v[76:79], v3 offset:3072
    s_cbranch_execz L_sk_27
    s_mov_b32 s34, 0
    s_waitcnt lgkmcnt(5)
    buffer_store_dwordx4 v[64:67], v4, s[24:27], s34 offen sc1
    s_mov_b32 s34, 57344
    s_waitcnt lgkmcnt(4)
    buffer_store_dwordx4 v[68:71], v4, s[24:27], s34 offen sc1
L_sk_27:
    v_pk_fma_f32 v[184:185], v[176:177], v[246:247], v[184:185] op_sel:[0,0,0] op_sel_hi:[1,0,1]
    v_pk_fma_f32 v[186:187], v[178:179], v[246:247], v[186:187] op_sel:[0,0,0] op_sel_hi:[1,0,1]
    v_pk_fma_f32 v[188:189], v[180:181], v[246:247], v[188:189] op_sel:[0,0,0] op_sel_hi:[1,0,1]
    v_pk_fma_f32 v[190:191], v[182:183], v[246:247], v[190:191] op_sel:[0,0,0] op_sel_hi:[1,0,1]
    v_pk_fma_f32 v[192:193], v[200:201], v[246:247], v[192:193] op_sel:[0,0,0] op_sel_hi:[1,0,1]
    v_pk_fma_f32 v[194:195], v[202:203], v[246:247], v[194:195] op_sel:[0,0,0] op_sel_hi:[1,0,1]
    v_pk_fma_f32 v[196:197], v[204:205], v[246:247], v[196:197] op_sel:[0,0,0] op_sel_hi:[1,0,1]
    v_pk_fma_f32 v[198:199], v[206:207], v[246:247], v[198:199] op_sel:[0,0,0] op_sel_hi:[1,0,1]
    v_pk_mul_f32 v[184:185], v[184:185], v[144:145]
    v_pk_mul_f32 v[186:187], v[186:187], v[146:147]
    v_pk_mul_f32 v[188:189], v[188:189], v[148:149]
    v_pk_mul_f32 v[190:191], v[190:191], v[150:151]
    v_pk_mul_f32 v[192:193], v[192:193], v[152:153]
    v_pk_mul_f32 v[194:195], v[194:195], v[154:155]
    v_pk_mul_f32 v[196:197], v[196:197], v[172:173]
    v_pk_mul_f32 v[198:199], v[198:199], v[174:175]
    v_cvt_pk_bf16_f32 v32, v184, v188
    v_cvt_pk_bf16_f32 v33, v185, v189
    v_cvt_pk_bf16_f32 v34, v186, v190
    v_cvt_pk_bf16_f32 v35, v187, v191
    ds_write_b128 v0, v[32:35] offset:4096
    v_cvt_pk_bf16_f32 v36, v192, v196
    v_cvt_pk_bf16_f32 v37, v193, v197
    v_cvt_pk_bf16_f32 v38, v194, v198
    v_cvt_pk_bf16_f32 v39, v195, v199
    ds_write_b128 v1, v[36:39] offset:4096
    ds_read_b128 v[80:83], v3 offset:4096
    ds_read_b128 v[84:87], v3 offset:5120
    s_cbranch_execz L_sk_28
    s_mov_b32 s34, 114688
    s_waitcnt lgkmcnt(5)
    buffer_store_dwordx4 v[72:75], v4, s[24:27], s34 offen sc1
    s_mov_b32 s34, 172032
    s_waitcnt lgkmcnt(4)
    buffer_store_dwordx4 v[76:79], v4, s[24:27], s34 offen sc1
L_sk_28:
    v_pk_fma_f32 v[212:213], v[176:177], v[246:247], v[212:213] op_sel:[0,1,0] op_sel_hi:[1,1,1]
    v_pk_fma_f32 v[214:215], v[178:179], v[246:247], v[214:215] op_sel:[0,1,0] op_sel_hi:[1,1,1]
    v_pk_fma_f32 v[216:217], v[180:181], v[246:247], v[216:217] op_sel:[0,1,0] op_sel_hi:[1,1,1]
    v_pk_fma_f32 v[218:219], v[182:183], v[246:247], v[218:219] op_sel:[0,1,0] op_sel_hi:[1,1,1]
    v_pk_fma_f32 v[220:221], v[200:201], v[246:247], v[220:221] op_sel:[0,1,0] op_sel_hi:[1,1,1]
    v_pk_fma_f32 v[222:223], v[202:203], v[246:247], v[222:223] op_sel:[0,1,0] op_sel_hi:[1,1,1]
    v_pk_fma_f32 v[224:225], v[204:205], v[246:247], v[224:225] op_sel:[0,1,0] op_sel_hi:[1,1,1]
    v_pk_fma_f32 v[226:227], v[206:207], v[246:247], v[226:227] op_sel:[0,1,0] op_sel_hi:[1,1,1]
    v_pk_mul_f32 v[212:213], v[212:213], v[144:145]
    v_pk_mul_f32 v[214:215], v[214:215], v[146:147]
    v_pk_mul_f32 v[216:217], v[216:217], v[148:149]
    v_pk_mul_f32 v[218:219], v[218:219], v[150:151]
    v_pk_mul_f32 v[220:221], v[220:221], v[152:153]
    v_pk_mul_f32 v[222:223], v[222:223], v[154:155]
    v_pk_mul_f32 v[224:225], v[224:225], v[172:173]
    v_pk_mul_f32 v[226:227], v[226:227], v[174:175]
    v_cvt_pk_bf16_f32 v40, v212, v216
    v_cvt_pk_bf16_f32 v41, v213, v217
    v_cvt_pk_bf16_f32 v42, v214, v218
    v_cvt_pk_bf16_f32 v43, v215, v219
    ds_write_b128 v0, v[40:43] offset:6144
    v_cvt_pk_bf16_f32 v44, v220, v224
    v_cvt_pk_bf16_f32 v45, v221, v225
    v_cvt_pk_bf16_f32 v46, v222, v226
    v_cvt_pk_bf16_f32 v47, v223, v227
    ds_write_b128 v1, v[44:47] offset:6144
    ds_read_b128 v[88:91], v3 offset:6144
    ds_read_b128 v[92:95], v3 offset:7168
    s_cbranch_execz L_sk_29
    s_mov_b32 s34, 229376
    s_waitcnt lgkmcnt(5)
    buffer_store_dwordx4 v[80:83], v4, s[24:27], s34 offen sc1
    s_mov_b32 s34, 286720
    s_waitcnt lgkmcnt(4)
    buffer_store_dwordx4 v[84:87], v4, s[24:27], s34 offen sc1
L_sk_29:
    s_cbranch_execz L_sk_30
    s_mov_b32 s34, 344064
    s_waitcnt lgkmcnt(1)
    buffer_store_dwordx4 v[88:91], v4, s[24:27], s34 offen sc1
    s_mov_b32 s34, 401408
    s_waitcnt lgkmcnt(0)
    buffer_store_dwordx4 v[92:95], v4, s[24:27], s34 offen sc1
L_sk_30:
    s_cbranch_execz L_dryret
    s_endpgm
L_fs_17:
L_w_31:
    ds_read_b32 v13, v12
    s_waitcnt lgkmcnt(0)
    v_cmp_gt_i32 vcc, s38, v13
    s_cbranch_vccz L_wo_32
    s_sub_u32 s90, s90, 1
    s_cmp_lt_i32 s90, 0
    s_cbranch_scc1 L_wo_32
    s_branch L_w_31
L_wo_32:
    s_branch L_fb_18
L_fs_19:
L_w_33:
    ds_read_b32 v13, v12
    s_waitcnt lgkmcnt(0)
    v_cmp_gt_i32 vcc, s38, v13
    s_cbranch_vccz L_wo_34
    s_sub_u32 s90, s90, 1
    s_cmp_lt_i32 s90, 0
    s_cbranch_scc1 L_wo_34
    s_branch L_w_33
L_wo_34:
    s_branch L_fb_20
L_fs_21:
L_w_35:
    ds_read_b32 v13, v12
    s_waitcnt lgkmcnt(0)
    v_cmp_gt_i32 vcc, 15, v13
    s_cbranch_vccz L_wo_36
    s_sub_u32 s90, s90, 1
    s_cmp_lt_i32 s90, 0
    s_cbranch_scc1 L_wo_36
    s_branch L_w_35
L_wo_36:
    s_branch L_fb_22
L_fs_23:
L_w_37:
    ds_read_b32 v13, v12
    s_waitcnt lgkmcnt(0)
    v_cmp_gt_i32 vcc, 16, v13
    s_cbranch_vccz L_wo_38
    s_sub_u32 s90, s90, 1
    s_cmp_lt_i32 s90, 0
    s_cbranch_scc1 L_wo_38
    s_branch L_w_37
L_wo_38:
    s_branch L_fb_24
L_fs_25:
L_w_39:
    ds_read_b32 v13, v5
    s_waitcnt lgkmcnt(0)
    v_cmp_gt_i32 vcc, 13, v13
    s_cbranch_vccz L_wo_40
    s_sub_u32 s90, s90, 1
    s_cmp_lt_i32 s90, 0
    s_cbranch_scc1 L_wo_40
    s_branch L_w_39
L_wo_40:
    s_branch L_fb_26
L_help:
    s_sub_u32 s40, s3, 4
    v_lshrrev_b32 v3, 4, v2
    v_and_b32 v4, 15, v2
    s_lshl_b32 s34, s40, 5
    v_add_u32 v5, s34, v3
    v_mul_u32_u24 v20, 192, v5
    v_lshrrev_b32 v21, 1, v3
    v_xor_b32 v21, v21, v4
    v_lshl_add_u32 v8, v21, 4, v20
    v_xor_b32 v21, 2, v21
    v_lshl_add_u32 v9, v21, 4, v20
    s_lshl_b32 s34, s30, 7
    v_add_u32 v5, s34, v5
    v_mul_u32_u24 v5, 7168, v5
    v_cmp_lt_u32 vcc, 3, v4
    v_mov_b32 v20, 128
    v_mov_b32 v21, 256
    v_cndmask_b32 v20, v20, v21, vcc
    v_lshl_add_u32 v20, v4, 4, v20
    s_mul_i32 s35, s31, 448
    v_add3_u32 v12, v5, v20, s35
    v_add_u32 v10, 32, v10
    s_mov_b32 s24, s20
    s_mov_b32 s25, s21
    s_mov_b32 s26, 14680064
    s_mov_b32 s27, 0x00020000
L_w_41:
    ds_read_b32 v11, v10
    s_waitcnt lgkmcnt(0)
    v_cmp_gt_i32 vcc, 1, v11
    s_cbranch_vccz L_wo_42
    s_sub_u32 s90, s90, 1
    s_cmp_lt_i32 s90, 0
    s_cbranch_scc1 L_wo_42
    s_sleep 2
    s_branch L_w_41
L_wo_42:
    v_cmp_gt_u32 vcc, 12, v4
    s_and_b64 exec, exec, vcc
    ds_read_b128 v[16:19], v8 offset:0
    ds_read_b128 v[20:23], v9 offset:768
    ds_read_b128 v[24:27], v8 offset:1536
    ds_read_b128 v[28:31], v9 offset:2304
    ds_read_b128 v[32:35], v8 offset:3072
    ds_read_b128 v[36:39], v9 offset:3840
    ds_read_b128 v[40:43], v8 offset:4608
    ds_read_b128 v[44:47], v9 offset:5376
    s_mov_b32 s34, 0
    s_waitcnt lgkmcnt(7)
    buffer_store_dwordx4 v[16:19], v12, s[24:27], s34 offen sc1
    s_mov_b32 s34, 28672
    s_waitcnt lgkmcnt(6)
    buffer_store_dwordx4 v[20:23], v12, s[24:27], s34 offen sc1
    s_mov_b32 s34, 57344
    s_waitcnt lgkmcnt(5)
    buffer_store_dwordx4 v[24:27], v12, s[24:27], s34 offen sc1
    s_mov_b32 s34, 86016
    s_waitcnt lgkmcnt(4)
    buffer_store_dwordx4 v[28:31], v12, s[24:27], s34 offen sc1
    s_mov_b32 s34, 114688
    s_waitcnt lgkmcnt(3)
    buffer_store_dwordx4 v[32:35], v12, s[24:27], s34 offen sc1
    s_mov_b32 s34, 143360
    s_waitcnt lgkmcnt(2)
    buffer_store_dwordx4 v[36:39], v12, s[24:27], s34 offen sc1
    s_mov_b32 s34, 172032
    s_waitcnt lgkmcnt(1)
    buffer_store_dwordx4 v[40:43], v12, s[24:27], s34 offen sc1
    s_mov_b32 s34, 200704
    s_waitcnt lgkmcnt(0)
    buffer_store_dwordx4 v[44:47], v12, s[24:27], s34 offen sc1
L_fin:
L_end:
    s_endpgm
.section .rodata,"a"
.p2align 6
.amdhsa_kernel standalone__w4a16_gemm_dequant__prompt_kernel
  .amdhsa_next_free_vgpr 256
  .amdhsa_next_free_sgpr 96
  .amdhsa_accum_offset 256
  .amdhsa_group_segment_fixed_size 0
  .amdhsa_kernarg_size 56
  .amdhsa_user_sgpr_count 2
  .amdhsa_user_sgpr_kernarg_segment_ptr 1
  .amdhsa_system_sgpr_workgroup_id_x 1
.end_amdhsa_kernel
```
